```python
import torch

def _softmax(x, axis=-1):
    return torch.softmax(x, dim=axis)

def _gelu(x):
    return torch.nn.functional.gelu(x, approximate='tanh')

def _silu(x):
    return torch.nn.functional.silu(x)

def _sigmoid(x):
    return torch.sigmoid(x)

def _layernorm(x, axis=-1, eps=1e-05):
    m = x.mean(dim=axis, keepdim=True)
    v = x.var(dim=axis, keepdim=True, unbiased=False)
    return (x - m) / torch.sqrt(v + eps)

def _scatter_add(tgt, idx, src, axis=0):
    return tgt.clone().index_add_(axis, idx, src)

def _segment_sum(src, seg, n):
    out = torch.zeros((n,) + src.shape[1:], dtype=src.dtype)
    return out.index_add_(0, seg, src)

def _pad(x, pw):
    flat = tuple((v for pair in reversed(pw) for v in pair))
    return torch.nn.functional.pad(x, flat)
kernel_name = 'adaLN_cond__mha_block_cached__swiglu_ffn__decode'

def setup_inputs():

    _w = lambda a: (lambda t: t.to(torch.bfloat16) if t.is_floating_point() else t)(torch.as_tensor(a))

    def _A_setup():
        B, Sq, D = (4, 1, 576)
        H, Sk, Dh = (32, 4096, 128)
        return {'x': _w((lambda *s: torch.randn(*s, dtype=torch.bfloat16) * 0.1)(B, Sq, D)), 'k_cache': _w((lambda *s: torch.randn(*s, dtype=torch.bfloat16) * 0.8)(B, H, Sk, Dh)), 'v_cache': _w((lambda *s: torch.randn(*s, dtype=torch.bfloat16) * 1.6)(B, H, Sk, Dh)), 'wq': _w((lambda *s: torch.randn(*s, dtype=torch.bfloat16) * 0.8)(D, H * Dh) * D ** (-0.5)), 'wo': _w((lambda *s: torch.randn(*s, dtype=torch.bfloat16) * 1.6)(H * Dh, D) * (H * Dh) ** (-0.5))}
    _A_in = _A_setup()

    def _B_setup():
        B, S, D, F = (4, 1, 576, 4608)
        return {'x': _w((lambda *s: torch.randn(*s, dtype=torch.bfloat16) * 0.1)(B, S, D)), 'w_gate': _w((lambda *s: torch.randn(*s, dtype=torch.bfloat16) * 0.2)(D, F)), 'w_up': _w((lambda *s: torch.randn(*s, dtype=torch.bfloat16) * 0.2)(D, F)), 'w_down': _w((lambda *s: torch.randn(*s, dtype=torch.bfloat16) * 0.2)(F, D))}
    _B_in = _B_setup()
    return {'A_x': _A_in['x'], 'A_k_cache': _A_in['k_cache'], 'A_v_cache': _A_in['v_cache'], 'A_wq': _A_in['wq'], 'A_wo': _A_in['wo'], 'B_x': _B_in['x'], 'B_w_gate': _B_in['w_gate'], 'B_w_up': _B_in['w_up'], 'B_w_down': _B_in['w_down'], 'c': _w((lambda *s: torch.randn(*s, dtype=torch.bfloat16) * 0.4)(4, 576) * 8.0), 'w_mod': _w((lambda *s: torch.randn(*s, dtype=torch.bfloat16) * 0.4)(576, 6 * 576) * 576 ** (-0.5) * 8.0)}

def reference(A_x, A_k_cache, A_v_cache, A_wq, A_wo, B_x, B_w_gate, B_w_up, B_w_down, c, w_mod):

    def _A_ref(x, k_cache, v_cache, wq, wo):
        B, Sq, D = x.shape
        H, Dh = (32, 128)
        q = (lambda x, *d: x.permute(*d))((x @ wq).reshape(B, Sq, H, Dh), 0, 2, 1, 3)
        scores = torch.einsum('bhqd,bhkd->bhqk', q, k_cache) * Dh ** (-0.5)
        p = _softmax(scores, axis=-1)
        o = torch.einsum('bhqk,bhkd->bhqd', p, v_cache)
        return (lambda x, *d: x.permute(*d))(o, 0, 2, 1, 3).reshape(B, Sq, H * Dh) @ wo

    def _B_ref(x, w_gate, w_up, w_down):
        g = _silu(x @ w_gate)
        u = x @ w_up
        return g * u @ w_down
    x = A_x
    mod = (_silu(c) @ w_mod).reshape(c.shape[0], 6, 1, -1)
    sa, ca, ga, sb, cb, gb = (mod[:, 0].clone(), mod[:, 1].clone(), mod[:, 2].clone(), mod[:, 3].clone(), mod[:, 4].clone(), mod[:, 5].clone())
    h = _layernorm(x, axis=-1) * (1 + ca) + sa
    x = x + ga * _A_ref(h, A_k_cache, A_v_cache, A_wq, A_wo)
    h = _layernorm(x, axis=-1) * (1 + cb) + sb
    x = x + gb * _B_ref(h, B_w_gate, B_w_up, B_w_down)
    return x
```

```asm
; @launch kernel=k0_mod_kernel grid=(108,1,1) block=(256,1,1) lds=49152
; @launch kernel=k1_q_kernel grid=(128,1,1) block=(256,1,1) lds=49152
; @launch kernel=k2_attn_kernel grid=(256,1,1) block=(512,1,1) lds=20480
; @launch kernel=k3_wo_kernel grid=(288,1,1) block=(256,1,1) lds=49152
; @launch kernel=k4_ffn1_kernel grid=(144,1,1) block=(256,1,1) lds=49152
; @launch kernel=k5_down_kernel grid=(324,1,1) block=(256,1,1) lds=49152
; @launch kernel=k6_fin_kernel grid=(9,1,1) block=(256,1,1) lds=0
.amdgcn_target "amdgcn-amd-amdhsa--gfx950"
.text
.globl k0_mod_kernel
.p2align 8
.type k0_mod_kernel,@function
k0_mod_kernel:
s_cmp_ge_u32 s2, 108
s_cbranch_scc1 k0_mod_kernel_done
s_load_dwordx2 s[4:5], s[0:1], 72
s_load_dwordx2 s[6:7], s[0:1], 80
s_load_dwordx2 s[8:9], s[0:1], 104
s_waitcnt lgkmcnt(0)
s_mov_b32 s12, s4
s_and_b32 s13, s5, 0xffff
s_mov_b32 s14, 4608
s_mov_b32 s15, 0x00020000
s_mov_b32 s16, s6
s_and_b32 s17, s7, 0xffff
s_mov_b32 s18, 3981312
s_mov_b32 s19, 0x00020000
s_mov_b32 s20, s8
s_and_b32 s21, s9, 0xffff
s_mov_b32 s22, 536870912
s_mov_b32 s23, 0x00020000
s_lshl_b32 s24, s2, 6
v_and_b32 v1, 63, v0
v_lshrrev_b32 v2, 6, v0
v_lshrrev_b32 v3, 2, v1
v_and_b32 v1, 3, v1
v_mad_u32_u24 v3, v2, 16, v3
s_mov_b32 s90, 6912
v_mul_lo_u32 v4, v3, s90
v_lshl_add_u32 v4, v1, 4, v4
s_mov_b32 s91, s24
buffer_load_dwordx4 v[160:163], v4, s[16:19], s91 offen
s_add_u32 s91, s91, 442368
buffer_load_dwordx4 v[164:167], v4, s[16:19], s91 offen
s_add_u32 s91, s91, 442368
buffer_load_dwordx4 v[168:171], v4, s[16:19], s91 offen
s_add_u32 s91, s91, 442368
buffer_load_dwordx4 v[172:175], v4, s[16:19], s91 offen
s_add_u32 s91, s91, 442368
buffer_load_dwordx4 v[176:179], v4, s[16:19], s91 offen
s_add_u32 s91, s91, 442368
buffer_load_dwordx4 v[180:183], v4, s[16:19], s91 offen
s_add_u32 s91, s91, 442368
buffer_load_dwordx4 v[184:187], v4, s[16:19], s91 offen
s_add_u32 s91, s91, 442368
buffer_load_dwordx4 v[188:191], v4, s[16:19], s91 offen
s_add_u32 s91, s91, 442368
buffer_load_dwordx4 v[192:195], v4, s[16:19], s91 offen
v_and_b32 v1, 63, v0
v_lshrrev_b32 v2, 6, v0
v_mul_u32_u24 v3, 576, v2
v_add_u32 v3, v3, v1
v_lshlrev_b32 v4, 1, v3
buffer_load_ushort v64, v4, s[12:15], 0 offen offset:0
buffer_load_ushort v65, v4, s[12:15], 0 offen offset:128
buffer_load_ushort v66, v4, s[12:15], 0 offen offset:256
buffer_load_ushort v67, v4, s[12:15], 0 offen offset:384
buffer_load_ushort v68, v4, s[12:15], 0 offen offset:512
buffer_load_ushort v69, v4, s[12:15], 0 offen offset:640
buffer_load_ushort v70, v4, s[12:15], 0 offen offset:768
buffer_load_ushort v71, v4, s[12:15], 0 offen offset:896
buffer_load_ushort v72, v4, s[12:15], 0 offen offset:1024
v_lshlrev_b32 v4, 4, v1
v_lshl_add_u32 v4, v2, 2, v4
s_waitcnt vmcnt(0)
v_lshlrev_b32 v64, 16, v64
v_mul_f32 v6, 0xbfb8aa3b, v64
v_exp_f32 v6, v6
s_nop 0
v_add_f32 v6, 1.0, v6
v_rcp_f32 v6, v6
s_nop 0
v_mul_f32 v6, v6, v64
v_cvt_pk_bf16_f32 v6, v6, v6
v_and_b32 v6, 0xffff0000, v6
ds_write_b32 v4, v6 offset:0
v_lshlrev_b32 v65, 16, v65
v_mul_f32 v6, 0xbfb8aa3b, v65
v_exp_f32 v6, v6
s_nop 0
v_add_f32 v6, 1.0, v6
v_rcp_f32 v6, v6
s_nop 0
v_mul_f32 v6, v6, v65
v_cvt_pk_bf16_f32 v6, v6, v6
v_and_b32 v6, 0xffff0000, v6
ds_write_b32 v4, v6 offset:1024
v_lshlrev_b32 v66, 16, v66
v_mul_f32 v6, 0xbfb8aa3b, v66
v_exp_f32 v6, v6
s_nop 0
v_add_f32 v6, 1.0, v6
v_rcp_f32 v6, v6
s_nop 0
v_mul_f32 v6, v6, v66
v_cvt_pk_bf16_f32 v6, v6, v6
v_and_b32 v6, 0xffff0000, v6
ds_write_b32 v4, v6 offset:2048
v_lshlrev_b32 v67, 16, v67
v_mul_f32 v6, 0xbfb8aa3b, v67
v_exp_f32 v6, v6
s_nop 0
v_add_f32 v6, 1.0, v6
v_rcp_f32 v6, v6
s_nop 0
v_mul_f32 v6, v6, v67
v_cvt_pk_bf16_f32 v6, v6, v6
v_and_b32 v6, 0xffff0000, v6
ds_write_b32 v4, v6 offset:3072
v_lshlrev_b32 v68, 16, v68
v_mul_f32 v6, 0xbfb8aa3b, v68
v_exp_f32 v6, v6
s_nop 0
v_add_f32 v6, 1.0, v6
v_rcp_f32 v6, v6
s_nop 0
v_mul_f32 v6, v6, v68
v_cvt_pk_bf16_f32 v6, v6, v6
v_and_b32 v6, 0xffff0000, v6
ds_write_b32 v4, v6 offset:4096
v_lshlrev_b32 v69, 16, v69
v_mul_f32 v6, 0xbfb8aa3b, v69
v_exp_f32 v6, v6
s_nop 0
v_add_f32 v6, 1.0, v6
v_rcp_f32 v6, v6
s_nop 0
v_mul_f32 v6, v6, v69
v_cvt_pk_bf16_f32 v6, v6, v6
v_and_b32 v6, 0xffff0000, v6
ds_write_b32 v4, v6 offset:5120
v_lshlrev_b32 v70, 16, v70
v_mul_f32 v6, 0xbfb8aa3b, v70
v_exp_f32 v6, v6
s_nop 0
v_add_f32 v6, 1.0, v6
v_rcp_f32 v6, v6
s_nop 0
v_mul_f32 v6, v6, v70
v_cvt_pk_bf16_f32 v6, v6, v6
v_and_b32 v6, 0xffff0000, v6
ds_write_b32 v4, v6 offset:6144
v_lshlrev_b32 v71, 16, v71
v_mul_f32 v6, 0xbfb8aa3b, v71
v_exp_f32 v6, v6
s_nop 0
v_add_f32 v6, 1.0, v6
v_rcp_f32 v6, v6
s_nop 0
v_mul_f32 v6, v6, v71
v_cvt_pk_bf16_f32 v6, v6, v6
v_and_b32 v6, 0xffff0000, v6
ds_write_b32 v4, v6 offset:7168
v_lshlrev_b32 v72, 16, v72
v_mul_f32 v6, 0xbfb8aa3b, v72
v_exp_f32 v6, v6
s_nop 0
v_add_f32 v6, 1.0, v6
v_rcp_f32 v6, v6
s_nop 0
v_mul_f32 v6, v6, v72
v_cvt_pk_bf16_f32 v6, v6, v6
v_and_b32 v6, 0xffff0000, v6
ds_write_b32 v4, v6 offset:8192
s_waitcnt lgkmcnt(0)
s_barrier
s_lshl_b32 s24, s2, 6
v_and_b32 v1, 63, v0
v_lshrrev_b32 v2, 6, v0
v_lshrrev_b32 v3, 2, v1
v_and_b32 v1, 3, v1
v_mad_u32_u24 v3, v2, 16, v3
s_mov_b32 s90, 6912
v_mul_lo_u32 v4, v3, s90
v_lshl_add_u32 v4, v1, 4, v4
s_mov_b32 s91, s24
v_lshlrev_b32 v5, 4, v3
ds_read_b128 v[64:67], v5 offset:0
ds_read_b128 v[68:71], v5 offset:1024
ds_read_b128 v[72:75], v5 offset:2048
ds_read_b128 v[76:79], v5 offset:3072
ds_read_b128 v[80:83], v5 offset:4096
ds_read_b128 v[84:87], v5 offset:5120
ds_read_b128 v[88:91], v5 offset:6144
ds_read_b128 v[92:95], v5 offset:7168
ds_read_b128 v[96:99], v5 offset:8192
v_mov_b32 v32, 0
v_mov_b32 v33, 0
v_mov_b32 v34, 0
v_mov_b32 v35, 0
v_mov_b32 v36, 0
v_mov_b32 v37, 0
v_mov_b32 v38, 0
v_mov_b32 v39, 0
v_mov_b32 v40, 0
v_mov_b32 v41, 0
v_mov_b32 v42, 0
v_mov_b32 v43, 0
v_mov_b32 v44, 0
v_mov_b32 v45, 0
v_mov_b32 v46, 0
v_mov_b32 v47, 0
v_mov_b32 v48, 0
v_mov_b32 v49, 0
v_mov_b32 v50, 0
v_mov_b32 v51, 0
v_mov_b32 v52, 0
v_mov_b32 v53, 0
v_mov_b32 v54, 0
v_mov_b32 v55, 0
v_mov_b32 v56, 0
v_mov_b32 v57, 0
v_mov_b32 v58, 0
v_mov_b32 v59, 0
v_mov_b32 v60, 0
v_mov_b32 v61, 0
v_mov_b32 v62, 0
v_mov_b32 v63, 0
s_waitcnt lgkmcnt(0)
s_waitcnt vmcnt(8)
v_lshlrev_b32 v6, 16, v160
v_and_b32 v7, 0xffff0000, v160
v_fmac_f32 v32, v64, v6
v_fmac_f32 v33, v64, v7
v_fmac_f32 v40, v65, v6
v_fmac_f32 v41, v65, v7
v_fmac_f32 v48, v66, v6
v_fmac_f32 v49, v66, v7
v_fmac_f32 v56, v67, v6
v_fmac_f32 v57, v67, v7
v_lshlrev_b32 v6, 16, v161
v_and_b32 v7, 0xffff0000, v161
v_fmac_f32 v34, v64, v6
v_fmac_f32 v35, v64, v7
v_fmac_f32 v42, v65, v6
v_fmac_f32 v43, v65, v7
v_fmac_f32 v50, v66, v6
v_fmac_f32 v51, v66, v7
v_fmac_f32 v58, v67, v6
v_fmac_f32 v59, v67, v7
v_lshlrev_b32 v6, 16, v162
v_and_b32 v7, 0xffff0000, v162
v_fmac_f32 v36, v64, v6
v_fmac_f32 v37, v64, v7
v_fmac_f32 v44, v65, v6
v_fmac_f32 v45, v65, v7
v_fmac_f32 v52, v66, v6
v_fmac_f32 v53, v66, v7
v_fmac_f32 v60, v67, v6
v_fmac_f32 v61, v67, v7
v_lshlrev_b32 v6, 16, v163
v_and_b32 v7, 0xffff0000, v163
v_fmac_f32 v38, v64, v6
v_fmac_f32 v39, v64, v7
v_fmac_f32 v46, v65, v6
v_fmac_f32 v47, v65, v7
v_fmac_f32 v54, v66, v6
v_fmac_f32 v55, v66, v7
v_fmac_f32 v62, v67, v6
v_fmac_f32 v63, v67, v7
s_waitcnt vmcnt(7)
v_lshlrev_b32 v6, 16, v164
v_and_b32 v7, 0xffff0000, v164
v_fmac_f32 v32, v68, v6
v_fmac_f32 v33, v68, v7
v_fmac_f32 v40, v69, v6
v_fmac_f32 v41, v69, v7
v_fmac_f32 v48, v70, v6
v_fmac_f32 v49, v70, v7
v_fmac_f32 v56, v71, v6
v_fmac_f32 v57, v71, v7
v_lshlrev_b32 v6, 16, v165
v_and_b32 v7, 0xffff0000, v165
v_fmac_f32 v34, v68, v6
v_fmac_f32 v35, v68, v7
v_fmac_f32 v42, v69, v6
v_fmac_f32 v43, v69, v7
v_fmac_f32 v50, v70, v6
v_fmac_f32 v51, v70, v7
v_fmac_f32 v58, v71, v6
v_fmac_f32 v59, v71, v7
v_lshlrev_b32 v6, 16, v166
v_and_b32 v7, 0xffff0000, v166
v_fmac_f32 v36, v68, v6
v_fmac_f32 v37, v68, v7
v_fmac_f32 v44, v69, v6
v_fmac_f32 v45, v69, v7
v_fmac_f32 v52, v70, v6
v_fmac_f32 v53, v70, v7
v_fmac_f32 v60, v71, v6
v_fmac_f32 v61, v71, v7
v_lshlrev_b32 v6, 16, v167
v_and_b32 v7, 0xffff0000, v167
v_fmac_f32 v38, v68, v6
v_fmac_f32 v39, v68, v7
v_fmac_f32 v46, v69, v6
v_fmac_f32 v47, v69, v7
v_fmac_f32 v54, v70, v6
v_fmac_f32 v55, v70, v7
v_fmac_f32 v62, v71, v6
v_fmac_f32 v63, v71, v7
s_waitcnt vmcnt(6)
v_lshlrev_b32 v6, 16, v168
v_and_b32 v7, 0xffff0000, v168
v_fmac_f32 v32, v72, v6
v_fmac_f32 v33, v72, v7
v_fmac_f32 v40, v73, v6
v_fmac_f32 v41, v73, v7
v_fmac_f32 v48, v74, v6
v_fmac_f32 v49, v74, v7
v_fmac_f32 v56, v75, v6
v_fmac_f32 v57, v75, v7
v_lshlrev_b32 v6, 16, v169
v_and_b32 v7, 0xffff0000, v169
v_fmac_f32 v34, v72, v6
v_fmac_f32 v35, v72, v7
v_fmac_f32 v42, v73, v6
v_fmac_f32 v43, v73, v7
v_fmac_f32 v50, v74, v6
v_fmac_f32 v51, v74, v7
v_fmac_f32 v58, v75, v6
v_fmac_f32 v59, v75, v7
v_lshlrev_b32 v6, 16, v170
v_and_b32 v7, 0xffff0000, v170
v_fmac_f32 v36, v72, v6
v_fmac_f32 v37, v72, v7
v_fmac_f32 v44, v73, v6
v_fmac_f32 v45, v73, v7
v_fmac_f32 v52, v74, v6
v_fmac_f32 v53, v74, v7
v_fmac_f32 v60, v75, v6
v_fmac_f32 v61, v75, v7
v_lshlrev_b32 v6, 16, v171
v_and_b32 v7, 0xffff0000, v171
v_fmac_f32 v38, v72, v6
v_fmac_f32 v39, v72, v7
v_fmac_f32 v46, v73, v6
v_fmac_f32 v47, v73, v7
v_fmac_f32 v54, v74, v6
v_fmac_f32 v55, v74, v7
v_fmac_f32 v62, v75, v6
v_fmac_f32 v63, v75, v7
s_waitcnt vmcnt(5)
v_lshlrev_b32 v6, 16, v172
v_and_b32 v7, 0xffff0000, v172
v_fmac_f32 v32, v76, v6
v_fmac_f32 v33, v76, v7
v_fmac_f32 v40, v77, v6
v_fmac_f32 v41, v77, v7
v_fmac_f32 v48, v78, v6
v_fmac_f32 v49, v78, v7
v_fmac_f32 v56, v79, v6
v_fmac_f32 v57, v79, v7
v_lshlrev_b32 v6, 16, v173
v_and_b32 v7, 0xffff0000, v173
v_fmac_f32 v34, v76, v6
v_fmac_f32 v35, v76, v7
v_fmac_f32 v42, v77, v6
v_fmac_f32 v43, v77, v7
v_fmac_f32 v50, v78, v6
v_fmac_f32 v51, v78, v7
v_fmac_f32 v58, v79, v6
v_fmac_f32 v59, v79, v7
v_lshlrev_b32 v6, 16, v174
v_and_b32 v7, 0xffff0000, v174
v_fmac_f32 v36, v76, v6
v_fmac_f32 v37, v76, v7
v_fmac_f32 v44, v77, v6
v_fmac_f32 v45, v77, v7
v_fmac_f32 v52, v78, v6
v_fmac_f32 v53, v78, v7
v_fmac_f32 v60, v79, v6
v_fmac_f32 v61, v79, v7
v_lshlrev_b32 v6, 16, v175
v_and_b32 v7, 0xffff0000, v175
v_fmac_f32 v38, v76, v6
v_fmac_f32 v39, v76, v7
v_fmac_f32 v46, v77, v6
v_fmac_f32 v47, v77, v7
v_fmac_f32 v54, v78, v6
v_fmac_f32 v55, v78, v7
v_fmac_f32 v62, v79, v6
v_fmac_f32 v63, v79, v7
s_waitcnt vmcnt(4)
v_lshlrev_b32 v6, 16, v176
v_and_b32 v7, 0xffff0000, v176
v_fmac_f32 v32, v80, v6
v_fmac_f32 v33, v80, v7
v_fmac_f32 v40, v81, v6
v_fmac_f32 v41, v81, v7
v_fmac_f32 v48, v82, v6
v_fmac_f32 v49, v82, v7
v_fmac_f32 v56, v83, v6
v_fmac_f32 v57, v83, v7
v_lshlrev_b32 v6, 16, v177
v_and_b32 v7, 0xffff0000, v177
v_fmac_f32 v34, v80, v6
v_fmac_f32 v35, v80, v7
v_fmac_f32 v42, v81, v6
v_fmac_f32 v43, v81, v7
v_fmac_f32 v50, v82, v6
v_fmac_f32 v51, v82, v7
v_fmac_f32 v58, v83, v6
v_fmac_f32 v59, v83, v7
v_lshlrev_b32 v6, 16, v178
v_and_b32 v7, 0xffff0000, v178
v_fmac_f32 v36, v80, v6
v_fmac_f32 v37, v80, v7
v_fmac_f32 v44, v81, v6
v_fmac_f32 v45, v81, v7
v_fmac_f32 v52, v82, v6
v_fmac_f32 v53, v82, v7
v_fmac_f32 v60, v83, v6
v_fmac_f32 v61, v83, v7
v_lshlrev_b32 v6, 16, v179
v_and_b32 v7, 0xffff0000, v179
v_fmac_f32 v38, v80, v6
v_fmac_f32 v39, v80, v7
v_fmac_f32 v46, v81, v6
v_fmac_f32 v47, v81, v7
v_fmac_f32 v54, v82, v6
v_fmac_f32 v55, v82, v7
v_fmac_f32 v62, v83, v6
v_fmac_f32 v63, v83, v7
s_waitcnt vmcnt(3)
v_lshlrev_b32 v6, 16, v180
v_and_b32 v7, 0xffff0000, v180
v_fmac_f32 v32, v84, v6
v_fmac_f32 v33, v84, v7
v_fmac_f32 v40, v85, v6
v_fmac_f32 v41, v85, v7
v_fmac_f32 v48, v86, v6
v_fmac_f32 v49, v86, v7
v_fmac_f32 v56, v87, v6
v_fmac_f32 v57, v87, v7
v_lshlrev_b32 v6, 16, v181
v_and_b32 v7, 0xffff0000, v181
v_fmac_f32 v34, v84, v6
v_fmac_f32 v35, v84, v7
v_fmac_f32 v42, v85, v6
v_fmac_f32 v43, v85, v7
v_fmac_f32 v50, v86, v6
v_fmac_f32 v51, v86, v7
v_fmac_f32 v58, v87, v6
v_fmac_f32 v59, v87, v7
v_lshlrev_b32 v6, 16, v182
v_and_b32 v7, 0xffff0000, v182
v_fmac_f32 v36, v84, v6
v_fmac_f32 v37, v84, v7
v_fmac_f32 v44, v85, v6
v_fmac_f32 v45, v85, v7
v_fmac_f32 v52, v86, v6
v_fmac_f32 v53, v86, v7
v_fmac_f32 v60, v87, v6
v_fmac_f32 v61, v87, v7
v_lshlrev_b32 v6, 16, v183
v_and_b32 v7, 0xffff0000, v183
v_fmac_f32 v38, v84, v6
v_fmac_f32 v39, v84, v7
v_fmac_f32 v46, v85, v6
v_fmac_f32 v47, v85, v7
v_fmac_f32 v54, v86, v6
v_fmac_f32 v55, v86, v7
v_fmac_f32 v62, v87, v6
v_fmac_f32 v63, v87, v7
s_waitcnt vmcnt(2)
v_lshlrev_b32 v6, 16, v184
v_and_b32 v7, 0xffff0000, v184
v_fmac_f32 v32, v88, v6
v_fmac_f32 v33, v88, v7
v_fmac_f32 v40, v89, v6
v_fmac_f32 v41, v89, v7
v_fmac_f32 v48, v90, v6
v_fmac_f32 v49, v90, v7
v_fmac_f32 v56, v91, v6
v_fmac_f32 v57, v91, v7
v_lshlrev_b32 v6, 16, v185
v_and_b32 v7, 0xffff0000, v185
v_fmac_f32 v34, v88, v6
v_fmac_f32 v35, v88, v7
v_fmac_f32 v42, v89, v6
v_fmac_f32 v43, v89, v7
v_fmac_f32 v50, v90, v6
v_fmac_f32 v51, v90, v7
v_fmac_f32 v58, v91, v6
v_fmac_f32 v59, v91, v7
v_lshlrev_b32 v6, 16, v186
v_and_b32 v7, 0xffff0000, v186
v_fmac_f32 v36, v88, v6
v_fmac_f32 v37, v88, v7
v_fmac_f32 v44, v89, v6
v_fmac_f32 v45, v89, v7
v_fmac_f32 v52, v90, v6
v_fmac_f32 v53, v90, v7
v_fmac_f32 v60, v91, v6
v_fmac_f32 v61, v91, v7
v_lshlrev_b32 v6, 16, v187
v_and_b32 v7, 0xffff0000, v187
v_fmac_f32 v38, v88, v6
v_fmac_f32 v39, v88, v7
v_fmac_f32 v46, v89, v6
v_fmac_f32 v47, v89, v7
v_fmac_f32 v54, v90, v6
v_fmac_f32 v55, v90, v7
v_fmac_f32 v62, v91, v6
v_fmac_f32 v63, v91, v7
s_waitcnt vmcnt(1)
v_lshlrev_b32 v6, 16, v188
v_and_b32 v7, 0xffff0000, v188
v_fmac_f32 v32, v92, v6
v_fmac_f32 v33, v92, v7
v_fmac_f32 v40, v93, v6
v_fmac_f32 v41, v93, v7
v_fmac_f32 v48, v94, v6
v_fmac_f32 v49, v94, v7
v_fmac_f32 v56, v95, v6
v_fmac_f32 v57, v95, v7
v_lshlrev_b32 v6, 16, v189
v_and_b32 v7, 0xffff0000, v189
v_fmac_f32 v34, v92, v6
v_fmac_f32 v35, v92, v7
v_fmac_f32 v42, v93, v6
v_fmac_f32 v43, v93, v7
v_fmac_f32 v50, v94, v6
v_fmac_f32 v51, v94, v7
v_fmac_f32 v58, v95, v6
v_fmac_f32 v59, v95, v7
v_lshlrev_b32 v6, 16, v190
v_and_b32 v7, 0xffff0000, v190
v_fmac_f32 v36, v92, v6
v_fmac_f32 v37, v92, v7
v_fmac_f32 v44, v93, v6
v_fmac_f32 v45, v93, v7
v_fmac_f32 v52, v94, v6
v_fmac_f32 v53, v94, v7
v_fmac_f32 v60, v95, v6
v_fmac_f32 v61, v95, v7
v_lshlrev_b32 v6, 16, v191
v_and_b32 v7, 0xffff0000, v191
v_fmac_f32 v38, v92, v6
v_fmac_f32 v39, v92, v7
v_fmac_f32 v46, v93, v6
v_fmac_f32 v47, v93, v7
v_fmac_f32 v54, v94, v6
v_fmac_f32 v55, v94, v7
v_fmac_f32 v62, v95, v6
v_fmac_f32 v63, v95, v7
s_waitcnt vmcnt(0)
v_lshlrev_b32 v6, 16, v192
v_and_b32 v7, 0xffff0000, v192
v_fmac_f32 v32, v96, v6
v_fmac_f32 v33, v96, v7
v_fmac_f32 v40, v97, v6
v_fmac_f32 v41, v97, v7
v_fmac_f32 v48, v98, v6
v_fmac_f32 v49, v98, v7
v_fmac_f32 v56, v99, v6
v_fmac_f32 v57, v99, v7
v_lshlrev_b32 v6, 16, v193
v_and_b32 v7, 0xffff0000, v193
v_fmac_f32 v34, v96, v6
v_fmac_f32 v35, v96, v7
v_fmac_f32 v42, v97, v6
v_fmac_f32 v43, v97, v7
v_fmac_f32 v50, v98, v6
v_fmac_f32 v51, v98, v7
v_fmac_f32 v58, v99, v6
v_fmac_f32 v59, v99, v7
v_lshlrev_b32 v6, 16, v194
v_and_b32 v7, 0xffff0000, v194
v_fmac_f32 v36, v96, v6
v_fmac_f32 v37, v96, v7
v_fmac_f32 v44, v97, v6
v_fmac_f32 v45, v97, v7
v_fmac_f32 v52, v98, v6
v_fmac_f32 v53, v98, v7
v_fmac_f32 v60, v99, v6
v_fmac_f32 v61, v99, v7
v_lshlrev_b32 v6, 16, v195
v_and_b32 v7, 0xffff0000, v195
v_fmac_f32 v38, v96, v6
v_fmac_f32 v39, v96, v7
v_fmac_f32 v46, v97, v6
v_fmac_f32 v47, v97, v7
v_fmac_f32 v54, v98, v6
v_fmac_f32 v55, v98, v7
v_fmac_f32 v62, v99, v6
v_fmac_f32 v63, v99, v7
v_mul_u32_u24 v5, 512, v3
v_lshl_add_u32 v5, v1, 5, v5
ds_write_b128 v5, v[32:35] offset:16384
ds_write_b128 v5, v[36:39] offset:16400
ds_write_b128 v5, v[40:43] offset:16512
ds_write_b128 v5, v[44:47] offset:16528
ds_write_b128 v5, v[48:51] offset:16640
ds_write_b128 v5, v[52:55] offset:16656
ds_write_b128 v5, v[56:59] offset:16768
ds_write_b128 v5, v[60:63] offset:16784
s_waitcnt lgkmcnt(0)
s_barrier
v_lshlrev_b32 v5, 2, v0
v_mov_b32 v10, 0
ds_read_b32 v64, v5 offset:16384
ds_read_b32 v65, v5 offset:16896
ds_read_b32 v66, v5 offset:17408
ds_read_b32 v67, v5 offset:17920
ds_read_b32 v68, v5 offset:18432
ds_read_b32 v69, v5 offset:18944
ds_read_b32 v70, v5 offset:19456
ds_read_b32 v71, v5 offset:19968
ds_read_b32 v72, v5 offset:20480
ds_read_b32 v73, v5 offset:20992
ds_read_b32 v74, v5 offset:21504
ds_read_b32 v75, v5 offset:22016
ds_read_b32 v76, v5 offset:22528
ds_read_b32 v77, v5 offset:23040
ds_read_b32 v78, v5 offset:23552
ds_read_b32 v79, v5 offset:24064
s_waitcnt lgkmcnt(0)
v_add_f32 v10, v10, v64
v_add_f32 v10, v10, v65
v_add_f32 v10, v10, v66
v_add_f32 v10, v10, v67
v_add_f32 v10, v10, v68
v_add_f32 v10, v10, v69
v_add_f32 v10, v10, v70
v_add_f32 v10, v10, v71
v_add_f32 v10, v10, v72
v_add_f32 v10, v10, v73
v_add_f32 v10, v10, v74
v_add_f32 v10, v10, v75
v_add_f32 v10, v10, v76
v_add_f32 v10, v10, v77
v_add_f32 v10, v10, v78
v_add_f32 v10, v10, v79
ds_read_b32 v64, v5 offset:24576
ds_read_b32 v65, v5 offset:25088
ds_read_b32 v66, v5 offset:25600
ds_read_b32 v67, v5 offset:26112
ds_read_b32 v68, v5 offset:26624
ds_read_b32 v69, v5 offset:27136
ds_read_b32 v70, v5 offset:27648
ds_read_b32 v71, v5 offset:28160
ds_read_b32 v72, v5 offset:28672
ds_read_b32 v73, v5 offset:29184
ds_read_b32 v74, v5 offset:29696
ds_read_b32 v75, v5 offset:30208
ds_read_b32 v76, v5 offset:30720
ds_read_b32 v77, v5 offset:31232
ds_read_b32 v78, v5 offset:31744
ds_read_b32 v79, v5 offset:32256
s_waitcnt lgkmcnt(0)
v_add_f32 v10, v10, v64
v_add_f32 v10, v10, v65
v_add_f32 v10, v10, v66
v_add_f32 v10, v10, v67
v_add_f32 v10, v10, v68
v_add_f32 v10, v10, v69
v_add_f32 v10, v10, v70
v_add_f32 v10, v10, v71
v_add_f32 v10, v10, v72
v_add_f32 v10, v10, v73
v_add_f32 v10, v10, v74
v_add_f32 v10, v10, v75
v_add_f32 v10, v10, v76
v_add_f32 v10, v10, v77
v_add_f32 v10, v10, v78
v_add_f32 v10, v10, v79
ds_read_b32 v64, v5 offset:32768
ds_read_b32 v65, v5 offset:33280
ds_read_b32 v66, v5 offset:33792
ds_read_b32 v67, v5 offset:34304
ds_read_b32 v68, v5 offset:34816
ds_read_b32 v69, v5 offset:35328
ds_read_b32 v70, v5 offset:35840
ds_read_b32 v71, v5 offset:36352
ds_read_b32 v72, v5 offset:36864
ds_read_b32 v73, v5 offset:37376
ds_read_b32 v74, v5 offset:37888
ds_read_b32 v75, v5 offset:38400
ds_read_b32 v76, v5 offset:38912
ds_read_b32 v77, v5 offset:39424
ds_read_b32 v78, v5 offset:39936
ds_read_b32 v79, v5 offset:40448
s_waitcnt lgkmcnt(0)
v_add_f32 v10, v10, v64
v_add_f32 v10, v10, v65
v_add_f32 v10, v10, v66
v_add_f32 v10, v10, v67
v_add_f32 v10, v10, v68
v_add_f32 v10, v10, v69
v_add_f32 v10, v10, v70
v_add_f32 v10, v10, v71
v_add_f32 v10, v10, v72
v_add_f32 v10, v10, v73
v_add_f32 v10, v10, v74
v_add_f32 v10, v10, v75
v_add_f32 v10, v10, v76
v_add_f32 v10, v10, v77
v_add_f32 v10, v10, v78
v_add_f32 v10, v10, v79
ds_read_b32 v64, v5 offset:40960
ds_read_b32 v65, v5 offset:41472
ds_read_b32 v66, v5 offset:41984
ds_read_b32 v67, v5 offset:42496
ds_read_b32 v68, v5 offset:43008
ds_read_b32 v69, v5 offset:43520
ds_read_b32 v70, v5 offset:44032
ds_read_b32 v71, v5 offset:44544
ds_read_b32 v72, v5 offset:45056
ds_read_b32 v73, v5 offset:45568
ds_read_b32 v74, v5 offset:46080
ds_read_b32 v75, v5 offset:46592
ds_read_b32 v76, v5 offset:47104
ds_read_b32 v77, v5 offset:47616
ds_read_b32 v78, v5 offset:48128
ds_read_b32 v79, v5 offset:48640
s_waitcnt lgkmcnt(0)
v_add_f32 v10, v10, v64
v_add_f32 v10, v10, v65
v_add_f32 v10, v10, v66
v_add_f32 v10, v10, v67
v_add_f32 v10, v10, v68
v_add_f32 v10, v10, v69
v_add_f32 v10, v10, v70
v_add_f32 v10, v10, v71
v_add_f32 v10, v10, v72
v_add_f32 v10, v10, v73
v_add_f32 v10, v10, v74
v_add_f32 v10, v10, v75
v_add_f32 v10, v10, v76
v_add_f32 v10, v10, v77
v_add_f32 v10, v10, v78
v_add_f32 v10, v10, v79
v_cvt_pk_bf16_f32 v10, v10, v10
v_and_b32 v10, 0xffff0000, v10
v_lshrrev_b32 v2, 5, v0
v_and_b32 v1, 31, v0
v_mul_u32_u24 v2, 3456, v2
v_add_u32 v2, v2, v1
s_lshl_b32 s25, s2, 5
v_add_u32 v2, s25, v2
v_lshlrev_b32 v2, 2, v2
v_cmp_gt_u32 vcc, 128, v0
s_and_saveexec_b64 s[26:27], vcc
buffer_store_dword v10, v2, s[20:23], 0 offen
s_mov_b64 exec, s[26:27]
s_cmp_ge_u32 s2, 9
s_cbranch_scc1 k0_mod_kernel_done
v_lshlrev_b32 v2, 2, v0
v_mov_b32 v3, 0
s_lshl_b32 s25, s2, 10
s_add_u32 s26, s25, 524288
s_add_u32 s27, s25, 655360
buffer_store_dword v3, v2, s[20:23], s26 offen
buffer_store_dword v3, v2, s[20:23], s27 offen
k0_mod_kernel_done:
s_endpgm
.globl k1_q_kernel
.p2align 8
.type k1_q_kernel,@function
k1_q_kernel:
s_cmp_ge_u32 s2, 128
s_cbranch_scc1 k1_q_kernel_done
s_load_dwordx2 s[4:5], s[0:1], 0
s_load_dwordx2 s[6:7], s[0:1], 24
s_load_dwordx2 s[8:9], s[0:1], 104
s_waitcnt lgkmcnt(0)
s_mov_b32 s12, s4
s_and_b32 s13, s5, 0xffff
s_mov_b32 s14, 4608
s_mov_b32 s15, 0x00020000
s_mov_b32 s16, s6
s_and_b32 s17, s7, 0xffff
s_mov_b32 s18, 4718592
s_mov_b32 s19, 0x00020000
s_mov_b32 s20, s8
s_and_b32 s21, s9, 0xffff
s_mov_b32 s22, 536870912
s_mov_b32 s23, 0x00020000
s_lshl_b32 s24, s2, 6
v_and_b32 v1, 63, v0
v_lshrrev_b32 v2, 6, v0
v_lshrrev_b32 v3, 2, v1
v_and_b32 v1, 3, v1
v_mad_u32_u24 v3, v2, 16, v3
s_mov_b32 s90, 8192
v_mul_lo_u32 v4, v3, s90
v_lshl_add_u32 v4, v1, 4, v4
s_mov_b32 s91, s24
buffer_load_dwordx4 v[160:163], v4, s[16:19], s91 offen
s_add_u32 s91, s91, 524288
buffer_load_dwordx4 v[164:167], v4, s[16:19], s91 offen
s_add_u32 s91, s91, 524288
buffer_load_dwordx4 v[168:171], v4, s[16:19], s91 offen
s_add_u32 s91, s91, 524288
buffer_load_dwordx4 v[172:175], v4, s[16:19], s91 offen
s_add_u32 s91, s91, 524288
buffer_load_dwordx4 v[176:179], v4, s[16:19], s91 offen
s_add_u32 s91, s91, 524288
buffer_load_dwordx4 v[180:183], v4, s[16:19], s91 offen
s_add_u32 s91, s91, 524288
buffer_load_dwordx4 v[184:187], v4, s[16:19], s91 offen
s_add_u32 s91, s91, 524288
buffer_load_dwordx4 v[188:191], v4, s[16:19], s91 offen
s_add_u32 s91, s91, 524288
buffer_load_dwordx4 v[192:195], v4, s[16:19], s91 offen
v_and_b32 v1, 63, v0
v_lshrrev_b32 v2, 6, v0
v_mul_u32_u24 v3, 576, v2
v_add_u32 v3, v3, v1
v_lshlrev_b32 v4, 1, v3
buffer_load_ushort v64, v4, s[12:15], 0 offen offset:0
buffer_load_ushort v65, v4, s[12:15], 0 offen offset:128
buffer_load_ushort v66, v4, s[12:15], 0 offen offset:256
buffer_load_ushort v67, v4, s[12:15], 0 offen offset:384
buffer_load_ushort v68, v4, s[12:15], 0 offen offset:512
buffer_load_ushort v69, v4, s[12:15], 0 offen offset:640
buffer_load_ushort v70, v4, s[12:15], 0 offen offset:768
buffer_load_ushort v71, v4, s[12:15], 0 offen offset:896
buffer_load_ushort v72, v4, s[12:15], 0 offen offset:1024
v_mul_u32_u24 v5, 3456, v2
v_add_u32 v5, v5, v1
v_lshlrev_b32 v5, 2, v5
s_mov_b32 s94, 2304
s_mov_b32 s95, 0
s_mov_b32 s96, 4608
buffer_load_dword v80, v5, s[20:23], s94 offen offset:0
buffer_load_dword v96, v5, s[20:23], s95 offen offset:0
buffer_load_dword v81, v5, s[20:23], s94 offen offset:256
buffer_load_dword v97, v5, s[20:23], s95 offen offset:256
buffer_load_dword v82, v5, s[20:23], s94 offen offset:512
buffer_load_dword v98, v5, s[20:23], s95 offen offset:512
buffer_load_dword v83, v5, s[20:23], s94 offen offset:768
buffer_load_dword v99, v5, s[20:23], s95 offen offset:768
buffer_load_dword v84, v5, s[20:23], s94 offen offset:1024
buffer_load_dword v100, v5, s[20:23], s95 offen offset:1024
buffer_load_dword v85, v5, s[20:23], s94 offen offset:1280
buffer_load_dword v101, v5, s[20:23], s95 offen offset:1280
buffer_load_dword v86, v5, s[20:23], s94 offen offset:1536
buffer_load_dword v102, v5, s[20:23], s95 offen offset:1536
buffer_load_dword v87, v5, s[20:23], s94 offen offset:1792
buffer_load_dword v103, v5, s[20:23], s95 offen offset:1792
buffer_load_dword v88, v5, s[20:23], s94 offen offset:2048
buffer_load_dword v104, v5, s[20:23], s95 offen offset:2048
s_waitcnt vmcnt(0)
v_lshlrev_b32 v64, 16, v64
v_lshlrev_b32 v65, 16, v65
v_lshlrev_b32 v66, 16, v66
v_lshlrev_b32 v67, 16, v67
v_lshlrev_b32 v68, 16, v68
v_lshlrev_b32 v69, 16, v69
v_lshlrev_b32 v70, 16, v70
v_lshlrev_b32 v71, 16, v71
v_lshlrev_b32 v72, 16, v72
v_mov_b32 v7, 0
v_add_f32 v7, v7, v64
v_add_f32 v7, v7, v65
v_add_f32 v7, v7, v66
v_add_f32 v7, v7, v67
v_add_f32 v7, v7, v68
v_add_f32 v7, v7, v69
v_add_f32 v7, v7, v70
v_add_f32 v7, v7, v71
v_add_f32 v7, v7, v72
s_nop 1
v_add_f32_dpp v7, v7, v7 row_shr:1 row_mask:0xf bank_mask:0xf bound_ctrl:0
s_nop 1
v_add_f32_dpp v7, v7, v7 row_shr:2 row_mask:0xf bank_mask:0xf bound_ctrl:0
s_nop 1
v_add_f32_dpp v7, v7, v7 row_shr:4 row_mask:0xf bank_mask:0xf bound_ctrl:0
s_nop 1
v_add_f32_dpp v7, v7, v7 row_shr:8 row_mask:0xf bank_mask:0xf bound_ctrl:0
s_nop 1
v_add_f32_dpp v7, v7, v7 row_bcast:15 row_mask:0xa bank_mask:0xf
s_nop 1
v_add_f32_dpp v7, v7, v7 row_bcast:31 row_mask:0xc bank_mask:0xf
s_nop 1
v_readlane_b32 s93, v7, 63
s_nop 3
v_mov_b32 v7, 0x3ae38e39
v_mul_f32 v8, s93, v7
v_mov_b32 v9, 0
v_sub_f32 v6, v64, v8
v_fmac_f32 v9, v6, v6
v_sub_f32 v6, v65, v8
v_fmac_f32 v9, v6, v6
v_sub_f32 v6, v66, v8
v_fmac_f32 v9, v6, v6
v_sub_f32 v6, v67, v8
v_fmac_f32 v9, v6, v6
v_sub_f32 v6, v68, v8
v_fmac_f32 v9, v6, v6
v_sub_f32 v6, v69, v8
v_fmac_f32 v9, v6, v6
v_sub_f32 v6, v70, v8
v_fmac_f32 v9, v6, v6
v_sub_f32 v6, v71, v8
v_fmac_f32 v9, v6, v6
v_sub_f32 v6, v72, v8
v_fmac_f32 v9, v6, v6
s_nop 1
v_add_f32_dpp v9, v9, v9 row_shr:1 row_mask:0xf bank_mask:0xf bound_ctrl:0
s_nop 1
v_add_f32_dpp v9, v9, v9 row_shr:2 row_mask:0xf bank_mask:0xf bound_ctrl:0
s_nop 1
v_add_f32_dpp v9, v9, v9 row_shr:4 row_mask:0xf bank_mask:0xf bound_ctrl:0
s_nop 1
v_add_f32_dpp v9, v9, v9 row_shr:8 row_mask:0xf bank_mask:0xf bound_ctrl:0
s_nop 1
v_add_f32_dpp v9, v9, v9 row_bcast:15 row_mask:0xa bank_mask:0xf
s_nop 1
v_add_f32_dpp v9, v9, v9 row_bcast:31 row_mask:0xc bank_mask:0xf
s_nop 1
v_readlane_b32 s93, v9, 63
s_nop 3
v_mul_f32 v9, s93, v7
v_cvt_pk_bf16_f32 v9, v9, v9
v_and_b32 v9, 0xffff0000, v9
v_add_f32 v9, 0x3727c5ac, v9
v_cvt_pk_bf16_f32 v9, v9, v9
v_and_b32 v9, 0xffff0000, v9
v_sqrt_f32 v9, v9
s_nop 0
v_cvt_pk_bf16_f32 v9, v9, v9
v_and_b32 v9, 0xffff0000, v9
v_rcp_f32 v11, v9
v_cvt_pk_bf16_f32 v8, v8, v8
v_and_b32 v8, 0xffff0000, v8
v_lshlrev_b32 v4, 4, v1
v_lshl_add_u32 v4, v2, 2, v4
v_sub_f32 v64, v64, v8
v_cvt_pk_bf16_f32 v64, v64, v64
v_and_b32 v64, 0xffff0000, v64
v_mul_f32 v6, v64, v11
v_fma_f32 v7, -v6, v9, v64
v_fmac_f32 v6, v7, v11
v_cvt_pk_bf16_f32 v6, v6, v6
v_and_b32 v6, 0xffff0000, v6
v_add_f32 v7, 1.0, v80
v_cvt_pk_bf16_f32 v7, v7, v7
v_and_b32 v7, 0xffff0000, v7
v_mul_f32 v6, v6, v7
v_cvt_pk_bf16_f32 v6, v6, v6
v_and_b32 v6, 0xffff0000, v6
v_add_f32 v6, v6, v96
v_cvt_pk_bf16_f32 v6, v6, v6
v_and_b32 v6, 0xffff0000, v6
ds_write_b32 v4, v6 offset:0
v_sub_f32 v65, v65, v8
v_cvt_pk_bf16_f32 v65, v65, v65
v_and_b32 v65, 0xffff0000, v65
v_mul_f32 v6, v65, v11
v_fma_f32 v7, -v6, v9, v65
v_fmac_f32 v6, v7, v11
v_cvt_pk_bf16_f32 v6, v6, v6
v_and_b32 v6, 0xffff0000, v6
v_add_f32 v7, 1.0, v81
v_cvt_pk_bf16_f32 v7, v7, v7
v_and_b32 v7, 0xffff0000, v7
v_mul_f32 v6, v6, v7
v_cvt_pk_bf16_f32 v6, v6, v6
v_and_b32 v6, 0xffff0000, v6
v_add_f32 v6, v6, v97
v_cvt_pk_bf16_f32 v6, v6, v6
v_and_b32 v6, 0xffff0000, v6
ds_write_b32 v4, v6 offset:1024
v_sub_f32 v66, v66, v8
v_cvt_pk_bf16_f32 v66, v66, v66
v_and_b32 v66, 0xffff0000, v66
v_mul_f32 v6, v66, v11
v_fma_f32 v7, -v6, v9, v66
v_fmac_f32 v6, v7, v11
v_cvt_pk_bf16_f32 v6, v6, v6
v_and_b32 v6, 0xffff0000, v6
v_add_f32 v7, 1.0, v82
v_cvt_pk_bf16_f32 v7, v7, v7
v_and_b32 v7, 0xffff0000, v7
v_mul_f32 v6, v6, v7
v_cvt_pk_bf16_f32 v6, v6, v6
v_and_b32 v6, 0xffff0000, v6
v_add_f32 v6, v6, v98
v_cvt_pk_bf16_f32 v6, v6, v6
v_and_b32 v6, 0xffff0000, v6
ds_write_b32 v4, v6 offset:2048
v_sub_f32 v67, v67, v8
v_cvt_pk_bf16_f32 v67, v67, v67
v_and_b32 v67, 0xffff0000, v67
v_mul_f32 v6, v67, v11
v_fma_f32 v7, -v6, v9, v67
v_fmac_f32 v6, v7, v11
v_cvt_pk_bf16_f32 v6, v6, v6
v_and_b32 v6, 0xffff0000, v6
v_add_f32 v7, 1.0, v83
v_cvt_pk_bf16_f32 v7, v7, v7
v_and_b32 v7, 0xffff0000, v7
v_mul_f32 v6, v6, v7
v_cvt_pk_bf16_f32 v6, v6, v6
v_and_b32 v6, 0xffff0000, v6
v_add_f32 v6, v6, v99
v_cvt_pk_bf16_f32 v6, v6, v6
v_and_b32 v6, 0xffff0000, v6
ds_write_b32 v4, v6 offset:3072
v_sub_f32 v68, v68, v8
v_cvt_pk_bf16_f32 v68, v68, v68
v_and_b32 v68, 0xffff0000, v68
v_mul_f32 v6, v68, v11
v_fma_f32 v7, -v6, v9, v68
v_fmac_f32 v6, v7, v11
v_cvt_pk_bf16_f32 v6, v6, v6
v_and_b32 v6, 0xffff0000, v6
v_add_f32 v7, 1.0, v84
v_cvt_pk_bf16_f32 v7, v7, v7
v_and_b32 v7, 0xffff0000, v7
v_mul_f32 v6, v6, v7
v_cvt_pk_bf16_f32 v6, v6, v6
v_and_b32 v6, 0xffff0000, v6
v_add_f32 v6, v6, v100
v_cvt_pk_bf16_f32 v6, v6, v6
v_and_b32 v6, 0xffff0000, v6
ds_write_b32 v4, v6 offset:4096
v_sub_f32 v69, v69, v8
v_cvt_pk_bf16_f32 v69, v69, v69
v_and_b32 v69, 0xffff0000, v69
v_mul_f32 v6, v69, v11
v_fma_f32 v7, -v6, v9, v69
v_fmac_f32 v6, v7, v11
v_cvt_pk_bf16_f32 v6, v6, v6
v_and_b32 v6, 0xffff0000, v6
v_add_f32 v7, 1.0, v85
v_cvt_pk_bf16_f32 v7, v7, v7
v_and_b32 v7, 0xffff0000, v7
v_mul_f32 v6, v6, v7
v_cvt_pk_bf16_f32 v6, v6, v6
v_and_b32 v6, 0xffff0000, v6
v_add_f32 v6, v6, v101
v_cvt_pk_bf16_f32 v6, v6, v6
v_and_b32 v6, 0xffff0000, v6
ds_write_b32 v4, v6 offset:5120
v_sub_f32 v70, v70, v8
v_cvt_pk_bf16_f32 v70, v70, v70
v_and_b32 v70, 0xffff0000, v70
v_mul_f32 v6, v70, v11
v_fma_f32 v7, -v6, v9, v70
v_fmac_f32 v6, v7, v11
v_cvt_pk_bf16_f32 v6, v6, v6
v_and_b32 v6, 0xffff0000, v6
v_add_f32 v7, 1.0, v86
v_cvt_pk_bf16_f32 v7, v7, v7
v_and_b32 v7, 0xffff0000, v7
v_mul_f32 v6, v6, v7
v_cvt_pk_bf16_f32 v6, v6, v6
v_and_b32 v6, 0xffff0000, v6
v_add_f32 v6, v6, v102
v_cvt_pk_bf16_f32 v6, v6, v6
v_and_b32 v6, 0xffff0000, v6
ds_write_b32 v4, v6 offset:6144
v_sub_f32 v71, v71, v8
v_cvt_pk_bf16_f32 v71, v71, v71
v_and_b32 v71, 0xffff0000, v71
v_mul_f32 v6, v71, v11
v_fma_f32 v7, -v6, v9, v71
v_fmac_f32 v6, v7, v11
v_cvt_pk_bf16_f32 v6, v6, v6
v_and_b32 v6, 0xffff0000, v6
v_add_f32 v7, 1.0, v87
v_cvt_pk_bf16_f32 v7, v7, v7
v_and_b32 v7, 0xffff0000, v7
v_mul_f32 v6, v6, v7
v_cvt_pk_bf16_f32 v6, v6, v6
v_and_b32 v6, 0xffff0000, v6
v_add_f32 v6, v6, v103
v_cvt_pk_bf16_f32 v6, v6, v6
v_and_b32 v6, 0xffff0000, v6
ds_write_b32 v4, v6 offset:7168
v_sub_f32 v72, v72, v8
v_cvt_pk_bf16_f32 v72, v72, v72
v_and_b32 v72, 0xffff0000, v72
v_mul_f32 v6, v72, v11
v_fma_f32 v7, -v6, v9, v72
v_fmac_f32 v6, v7, v11
v_cvt_pk_bf16_f32 v6, v6, v6
v_and_b32 v6, 0xffff0000, v6
v_add_f32 v7, 1.0, v88
v_cvt_pk_bf16_f32 v7, v7, v7
v_and_b32 v7, 0xffff0000, v7
v_mul_f32 v6, v6, v7
v_cvt_pk_bf16_f32 v6, v6, v6
v_and_b32 v6, 0xffff0000, v6
v_add_f32 v6, v6, v104
v_cvt_pk_bf16_f32 v6, v6, v6
v_and_b32 v6, 0xffff0000, v6
ds_write_b32 v4, v6 offset:8192
s_waitcnt lgkmcnt(0)
s_barrier
s_lshl_b32 s24, s2, 6
v_and_b32 v1, 63, v0
v_lshrrev_b32 v2, 6, v0
v_lshrrev_b32 v3, 2, v1
v_and_b32 v1, 3, v1
v_mad_u32_u24 v3, v2, 16, v3
s_mov_b32 s90, 8192
v_mul_lo_u32 v4, v3, s90
v_lshl_add_u32 v4, v1, 4, v4
s_mov_b32 s91, s24
v_lshlrev_b32 v5, 4, v3
ds_read_b128 v[64:67], v5 offset:0
ds_read_b128 v[68:71], v5 offset:1024
ds_read_b128 v[72:75], v5 offset:2048
ds_read_b128 v[76:79], v5 offset:3072
ds_read_b128 v[80:83], v5 offset:4096
ds_read_b128 v[84:87], v5 offset:5120
ds_read_b128 v[88:91], v5 offset:6144
ds_read_b128 v[92:95], v5 offset:7168
ds_read_b128 v[96:99], v5 offset:8192
v_mov_b32 v32, 0
v_mov_b32 v33, 0
v_mov_b32 v34, 0
v_mov_b32 v35, 0
v_mov_b32 v36, 0
v_mov_b32 v37, 0
v_mov_b32 v38, 0
v_mov_b32 v39, 0
v_mov_b32 v40, 0
v_mov_b32 v41, 0
v_mov_b32 v42, 0
v_mov_b32 v43, 0
v_mov_b32 v44, 0
v_mov_b32 v45, 0
v_mov_b32 v46, 0
v_mov_b32 v47, 0
v_mov_b32 v48, 0
v_mov_b32 v49, 0
v_mov_b32 v50, 0
v_mov_b32 v51, 0
v_mov_b32 v52, 0
v_mov_b32 v53, 0
v_mov_b32 v54, 0
v_mov_b32 v55, 0
v_mov_b32 v56, 0
v_mov_b32 v57, 0
v_mov_b32 v58, 0
v_mov_b32 v59, 0
v_mov_b32 v60, 0
v_mov_b32 v61, 0
v_mov_b32 v62, 0
v_mov_b32 v63, 0
s_waitcnt lgkmcnt(0)
s_waitcnt vmcnt(8)
v_lshlrev_b32 v6, 16, v160
v_and_b32 v7, 0xffff0000, v160
v_fmac_f32 v32, v64, v6
v_fmac_f32 v33, v64, v7
v_fmac_f32 v40, v65, v6
v_fmac_f32 v41, v65, v7
v_fmac_f32 v48, v66, v6
v_fmac_f32 v49, v66, v7
v_fmac_f32 v56, v67, v6
v_fmac_f32 v57, v67, v7
v_lshlrev_b32 v6, 16, v161
v_and_b32 v7, 0xffff0000, v161
v_fmac_f32 v34, v64, v6
v_fmac_f32 v35, v64, v7
v_fmac_f32 v42, v65, v6
v_fmac_f32 v43, v65, v7
v_fmac_f32 v50, v66, v6
v_fmac_f32 v51, v66, v7
v_fmac_f32 v58, v67, v6
v_fmac_f32 v59, v67, v7
v_lshlrev_b32 v6, 16, v162
v_and_b32 v7, 0xffff0000, v162
v_fmac_f32 v36, v64, v6
v_fmac_f32 v37, v64, v7
v_fmac_f32 v44, v65, v6
v_fmac_f32 v45, v65, v7
v_fmac_f32 v52, v66, v6
v_fmac_f32 v53, v66, v7
v_fmac_f32 v60, v67, v6
v_fmac_f32 v61, v67, v7
v_lshlrev_b32 v6, 16, v163
v_and_b32 v7, 0xffff0000, v163
v_fmac_f32 v38, v64, v6
v_fmac_f32 v39, v64, v7
v_fmac_f32 v46, v65, v6
v_fmac_f32 v47, v65, v7
v_fmac_f32 v54, v66, v6
v_fmac_f32 v55, v66, v7
v_fmac_f32 v62, v67, v6
v_fmac_f32 v63, v67, v7
s_waitcnt vmcnt(7)
v_lshlrev_b32 v6, 16, v164
v_and_b32 v7, 0xffff0000, v164
v_fmac_f32 v32, v68, v6
v_fmac_f32 v33, v68, v7
v_fmac_f32 v40, v69, v6
v_fmac_f32 v41, v69, v7
v_fmac_f32 v48, v70, v6
v_fmac_f32 v49, v70, v7
v_fmac_f32 v56, v71, v6
v_fmac_f32 v57, v71, v7
v_lshlrev_b32 v6, 16, v165
v_and_b32 v7, 0xffff0000, v165
v_fmac_f32 v34, v68, v6
v_fmac_f32 v35, v68, v7
v_fmac_f32 v42, v69, v6
v_fmac_f32 v43, v69, v7
v_fmac_f32 v50, v70, v6
v_fmac_f32 v51, v70, v7
v_fmac_f32 v58, v71, v6
v_fmac_f32 v59, v71, v7
v_lshlrev_b32 v6, 16, v166
v_and_b32 v7, 0xffff0000, v166
v_fmac_f32 v36, v68, v6
v_fmac_f32 v37, v68, v7
v_fmac_f32 v44, v69, v6
v_fmac_f32 v45, v69, v7
v_fmac_f32 v52, v70, v6
v_fmac_f32 v53, v70, v7
v_fmac_f32 v60, v71, v6
v_fmac_f32 v61, v71, v7
v_lshlrev_b32 v6, 16, v167
v_and_b32 v7, 0xffff0000, v167
v_fmac_f32 v38, v68, v6
v_fmac_f32 v39, v68, v7
v_fmac_f32 v46, v69, v6
v_fmac_f32 v47, v69, v7
v_fmac_f32 v54, v70, v6
v_fmac_f32 v55, v70, v7
v_fmac_f32 v62, v71, v6
v_fmac_f32 v63, v71, v7
s_waitcnt vmcnt(6)
v_lshlrev_b32 v6, 16, v168
v_and_b32 v7, 0xffff0000, v168
v_fmac_f32 v32, v72, v6
v_fmac_f32 v33, v72, v7
v_fmac_f32 v40, v73, v6
v_fmac_f32 v41, v73, v7
v_fmac_f32 v48, v74, v6
v_fmac_f32 v49, v74, v7
v_fmac_f32 v56, v75, v6
v_fmac_f32 v57, v75, v7
v_lshlrev_b32 v6, 16, v169
v_and_b32 v7, 0xffff0000, v169
v_fmac_f32 v34, v72, v6
v_fmac_f32 v35, v72, v7
v_fmac_f32 v42, v73, v6
v_fmac_f32 v43, v73, v7
v_fmac_f32 v50, v74, v6
v_fmac_f32 v51, v74, v7
v_fmac_f32 v58, v75, v6
v_fmac_f32 v59, v75, v7
v_lshlrev_b32 v6, 16, v170
v_and_b32 v7, 0xffff0000, v170
v_fmac_f32 v36, v72, v6
v_fmac_f32 v37, v72, v7
v_fmac_f32 v44, v73, v6
v_fmac_f32 v45, v73, v7
v_fmac_f32 v52, v74, v6
v_fmac_f32 v53, v74, v7
v_fmac_f32 v60, v75, v6
v_fmac_f32 v61, v75, v7
v_lshlrev_b32 v6, 16, v171
v_and_b32 v7, 0xffff0000, v171
v_fmac_f32 v38, v72, v6
v_fmac_f32 v39, v72, v7
v_fmac_f32 v46, v73, v6
v_fmac_f32 v47, v73, v7
v_fmac_f32 v54, v74, v6
v_fmac_f32 v55, v74, v7
v_fmac_f32 v62, v75, v6
v_fmac_f32 v63, v75, v7
s_waitcnt vmcnt(5)
v_lshlrev_b32 v6, 16, v172
v_and_b32 v7, 0xffff0000, v172
v_fmac_f32 v32, v76, v6
v_fmac_f32 v33, v76, v7
v_fmac_f32 v40, v77, v6
v_fmac_f32 v41, v77, v7
v_fmac_f32 v48, v78, v6
v_fmac_f32 v49, v78, v7
v_fmac_f32 v56, v79, v6
v_fmac_f32 v57, v79, v7
v_lshlrev_b32 v6, 16, v173
v_and_b32 v7, 0xffff0000, v173
v_fmac_f32 v34, v76, v6
v_fmac_f32 v35, v76, v7
v_fmac_f32 v42, v77, v6
v_fmac_f32 v43, v77, v7
v_fmac_f32 v50, v78, v6
v_fmac_f32 v51, v78, v7
v_fmac_f32 v58, v79, v6
v_fmac_f32 v59, v79, v7
v_lshlrev_b32 v6, 16, v174
v_and_b32 v7, 0xffff0000, v174
v_fmac_f32 v36, v76, v6
v_fmac_f32 v37, v76, v7
v_fmac_f32 v44, v77, v6
v_fmac_f32 v45, v77, v7
v_fmac_f32 v52, v78, v6
v_fmac_f32 v53, v78, v7
v_fmac_f32 v60, v79, v6
v_fmac_f32 v61, v79, v7
v_lshlrev_b32 v6, 16, v175
v_and_b32 v7, 0xffff0000, v175
v_fmac_f32 v38, v76, v6
v_fmac_f32 v39, v76, v7
v_fmac_f32 v46, v77, v6
v_fmac_f32 v47, v77, v7
v_fmac_f32 v54, v78, v6
v_fmac_f32 v55, v78, v7
v_fmac_f32 v62, v79, v6
v_fmac_f32 v63, v79, v7
s_waitcnt vmcnt(4)
v_lshlrev_b32 v6, 16, v176
v_and_b32 v7, 0xffff0000, v176
v_fmac_f32 v32, v80, v6
v_fmac_f32 v33, v80, v7
v_fmac_f32 v40, v81, v6
v_fmac_f32 v41, v81, v7
v_fmac_f32 v48, v82, v6
v_fmac_f32 v49, v82, v7
v_fmac_f32 v56, v83, v6
v_fmac_f32 v57, v83, v7
v_lshlrev_b32 v6, 16, v177
v_and_b32 v7, 0xffff0000, v177
v_fmac_f32 v34, v80, v6
v_fmac_f32 v35, v80, v7
v_fmac_f32 v42, v81, v6
v_fmac_f32 v43, v81, v7
v_fmac_f32 v50, v82, v6
v_fmac_f32 v51, v82, v7
v_fmac_f32 v58, v83, v6
v_fmac_f32 v59, v83, v7
v_lshlrev_b32 v6, 16, v178
v_and_b32 v7, 0xffff0000, v178
v_fmac_f32 v36, v80, v6
v_fmac_f32 v37, v80, v7
v_fmac_f32 v44, v81, v6
v_fmac_f32 v45, v81, v7
v_fmac_f32 v52, v82, v6
v_fmac_f32 v53, v82, v7
v_fmac_f32 v60, v83, v6
v_fmac_f32 v61, v83, v7
v_lshlrev_b32 v6, 16, v179
v_and_b32 v7, 0xffff0000, v179
v_fmac_f32 v38, v80, v6
v_fmac_f32 v39, v80, v7
v_fmac_f32 v46, v81, v6
v_fmac_f32 v47, v81, v7
v_fmac_f32 v54, v82, v6
v_fmac_f32 v55, v82, v7
v_fmac_f32 v62, v83, v6
v_fmac_f32 v63, v83, v7
s_waitcnt vmcnt(3)
v_lshlrev_b32 v6, 16, v180
v_and_b32 v7, 0xffff0000, v180
v_fmac_f32 v32, v84, v6
v_fmac_f32 v33, v84, v7
v_fmac_f32 v40, v85, v6
v_fmac_f32 v41, v85, v7
v_fmac_f32 v48, v86, v6
v_fmac_f32 v49, v86, v7
v_fmac_f32 v56, v87, v6
v_fmac_f32 v57, v87, v7
v_lshlrev_b32 v6, 16, v181
v_and_b32 v7, 0xffff0000, v181
v_fmac_f32 v34, v84, v6
v_fmac_f32 v35, v84, v7
v_fmac_f32 v42, v85, v6
v_fmac_f32 v43, v85, v7
v_fmac_f32 v50, v86, v6
v_fmac_f32 v51, v86, v7
v_fmac_f32 v58, v87, v6
v_fmac_f32 v59, v87, v7
v_lshlrev_b32 v6, 16, v182
v_and_b32 v7, 0xffff0000, v182
v_fmac_f32 v36, v84, v6
v_fmac_f32 v37, v84, v7
v_fmac_f32 v44, v85, v6
v_fmac_f32 v45, v85, v7
v_fmac_f32 v52, v86, v6
v_fmac_f32 v53, v86, v7
v_fmac_f32 v60, v87, v6
v_fmac_f32 v61, v87, v7
v_lshlrev_b32 v6, 16, v183
v_and_b32 v7, 0xffff0000, v183
v_fmac_f32 v38, v84, v6
v_fmac_f32 v39, v84, v7
v_fmac_f32 v46, v85, v6
v_fmac_f32 v47, v85, v7
v_fmac_f32 v54, v86, v6
v_fmac_f32 v55, v86, v7
v_fmac_f32 v62, v87, v6
v_fmac_f32 v63, v87, v7
s_waitcnt vmcnt(2)
v_lshlrev_b32 v6, 16, v184
v_and_b32 v7, 0xffff0000, v184
v_fmac_f32 v32, v88, v6
v_fmac_f32 v33, v88, v7
v_fmac_f32 v40, v89, v6
v_fmac_f32 v41, v89, v7
v_fmac_f32 v48, v90, v6
v_fmac_f32 v49, v90, v7
v_fmac_f32 v56, v91, v6
v_fmac_f32 v57, v91, v7
v_lshlrev_b32 v6, 16, v185
v_and_b32 v7, 0xffff0000, v185
v_fmac_f32 v34, v88, v6
v_fmac_f32 v35, v88, v7
v_fmac_f32 v42, v89, v6
v_fmac_f32 v43, v89, v7
v_fmac_f32 v50, v90, v6
v_fmac_f32 v51, v90, v7
v_fmac_f32 v58, v91, v6
v_fmac_f32 v59, v91, v7
v_lshlrev_b32 v6, 16, v186
v_and_b32 v7, 0xffff0000, v186
v_fmac_f32 v36, v88, v6
v_fmac_f32 v37, v88, v7
v_fmac_f32 v44, v89, v6
v_fmac_f32 v45, v89, v7
v_fmac_f32 v52, v90, v6
v_fmac_f32 v53, v90, v7
v_fmac_f32 v60, v91, v6
v_fmac_f32 v61, v91, v7
v_lshlrev_b32 v6, 16, v187
v_and_b32 v7, 0xffff0000, v187
v_fmac_f32 v38, v88, v6
v_fmac_f32 v39, v88, v7
v_fmac_f32 v46, v89, v6
v_fmac_f32 v47, v89, v7
v_fmac_f32 v54, v90, v6
v_fmac_f32 v55, v90, v7
v_fmac_f32 v62, v91, v6
v_fmac_f32 v63, v91, v7
s_waitcnt vmcnt(1)
v_lshlrev_b32 v6, 16, v188
v_and_b32 v7, 0xffff0000, v188
v_fmac_f32 v32, v92, v6
v_fmac_f32 v33, v92, v7
v_fmac_f32 v40, v93, v6
v_fmac_f32 v41, v93, v7
v_fmac_f32 v48, v94, v6
v_fmac_f32 v49, v94, v7
v_fmac_f32 v56, v95, v6
v_fmac_f32 v57, v95, v7
v_lshlrev_b32 v6, 16, v189
v_and_b32 v7, 0xffff0000, v189
v_fmac_f32 v34, v92, v6
v_fmac_f32 v35, v92, v7
v_fmac_f32 v42, v93, v6
v_fmac_f32 v43, v93, v7
v_fmac_f32 v50, v94, v6
v_fmac_f32 v51, v94, v7
v_fmac_f32 v58, v95, v6
v_fmac_f32 v59, v95, v7
v_lshlrev_b32 v6, 16, v190
v_and_b32 v7, 0xffff0000, v190
v_fmac_f32 v36, v92, v6
v_fmac_f32 v37, v92, v7
v_fmac_f32 v44, v93, v6
v_fmac_f32 v45, v93, v7
v_fmac_f32 v52, v94, v6
v_fmac_f32 v53, v94, v7
v_fmac_f32 v60, v95, v6
v_fmac_f32 v61, v95, v7
v_lshlrev_b32 v6, 16, v191
v_and_b32 v7, 0xffff0000, v191
v_fmac_f32 v38, v92, v6
v_fmac_f32 v39, v92, v7
v_fmac_f32 v46, v93, v6
v_fmac_f32 v47, v93, v7
v_fmac_f32 v54, v94, v6
v_fmac_f32 v55, v94, v7
v_fmac_f32 v62, v95, v6
v_fmac_f32 v63, v95, v7
s_waitcnt vmcnt(0)
v_lshlrev_b32 v6, 16, v192
v_and_b32 v7, 0xffff0000, v192
v_fmac_f32 v32, v96, v6
v_fmac_f32 v33, v96, v7
v_fmac_f32 v40, v97, v6
v_fmac_f32 v41, v97, v7
v_fmac_f32 v48, v98, v6
v_fmac_f32 v49, v98, v7
v_fmac_f32 v56, v99, v6
v_fmac_f32 v57, v99, v7
v_lshlrev_b32 v6, 16, v193
v_and_b32 v7, 0xffff0000, v193
v_fmac_f32 v34, v96, v6
v_fmac_f32 v35, v96, v7
v_fmac_f32 v42, v97, v6
v_fmac_f32 v43, v97, v7
v_fmac_f32 v50, v98, v6
v_fmac_f32 v51, v98, v7
v_fmac_f32 v58, v99, v6
v_fmac_f32 v59, v99, v7
v_lshlrev_b32 v6, 16, v194
v_and_b32 v7, 0xffff0000, v194
v_fmac_f32 v36, v96, v6
v_fmac_f32 v37, v96, v7
v_fmac_f32 v44, v97, v6
v_fmac_f32 v45, v97, v7
v_fmac_f32 v52, v98, v6
v_fmac_f32 v53, v98, v7
v_fmac_f32 v60, v99, v6
v_fmac_f32 v61, v99, v7
v_lshlrev_b32 v6, 16, v195
v_and_b32 v7, 0xffff0000, v195
v_fmac_f32 v38, v96, v6
v_fmac_f32 v39, v96, v7
v_fmac_f32 v46, v97, v6
v_fmac_f32 v47, v97, v7
v_fmac_f32 v54, v98, v6
v_fmac_f32 v55, v98, v7
v_fmac_f32 v62, v99, v6
v_fmac_f32 v63, v99, v7
v_mul_u32_u24 v5, 512, v3
v_lshl_add_u32 v5, v1, 5, v5
ds_write_b128 v5, v[32:35] offset:16384
ds_write_b128 v5, v[36:39] offset:16400
ds_write_b128 v5, v[40:43] offset:16512
ds_write_b128 v5, v[44:47] offset:16528
ds_write_b128 v5, v[48:51] offset:16640
ds_write_b128 v5, v[52:55] offset:16656
ds_write_b128 v5, v[56:59] offset:16768
ds_write_b128 v5, v[60:63] offset:16784
s_waitcnt lgkmcnt(0)
s_barrier
v_lshlrev_b32 v5, 2, v0
v_mov_b32 v10, 0
ds_read_b32 v64, v5 offset:16384
ds_read_b32 v65, v5 offset:16896
ds_read_b32 v66, v5 offset:17408
ds_read_b32 v67, v5 offset:17920
ds_read_b32 v68, v5 offset:18432
ds_read_b32 v69, v5 offset:18944
ds_read_b32 v70, v5 offset:19456
ds_read_b32 v71, v5 offset:19968
ds_read_b32 v72, v5 offset:20480
ds_read_b32 v73, v5 offset:20992
ds_read_b32 v74, v5 offset:21504
ds_read_b32 v75, v5 offset:22016
ds_read_b32 v76, v5 offset:22528
ds_read_b32 v77, v5 offset:23040
ds_read_b32 v78, v5 offset:23552
ds_read_b32 v79, v5 offset:24064
s_waitcnt lgkmcnt(0)
v_add_f32 v10, v10, v64
v_add_f32 v10, v10, v65
v_add_f32 v10, v10, v66
v_add_f32 v10, v10, v67
v_add_f32 v10, v10, v68
v_add_f32 v10, v10, v69
v_add_f32 v10, v10, v70
v_add_f32 v10, v10, v71
v_add_f32 v10, v10, v72
v_add_f32 v10, v10, v73
v_add_f32 v10, v10, v74
v_add_f32 v10, v10, v75
v_add_f32 v10, v10, v76
v_add_f32 v10, v10, v77
v_add_f32 v10, v10, v78
v_add_f32 v10, v10, v79
ds_read_b32 v64, v5 offset:24576
ds_read_b32 v65, v5 offset:25088
ds_read_b32 v66, v5 offset:25600
ds_read_b32 v67, v5 offset:26112
ds_read_b32 v68, v5 offset:26624
ds_read_b32 v69, v5 offset:27136
ds_read_b32 v70, v5 offset:27648
ds_read_b32 v71, v5 offset:28160
ds_read_b32 v72, v5 offset:28672
ds_read_b32 v73, v5 offset:29184
ds_read_b32 v74, v5 offset:29696
ds_read_b32 v75, v5 offset:30208
ds_read_b32 v76, v5 offset:30720
ds_read_b32 v77, v5 offset:31232
ds_read_b32 v78, v5 offset:31744
ds_read_b32 v79, v5 offset:32256
s_waitcnt lgkmcnt(0)
v_add_f32 v10, v10, v64
v_add_f32 v10, v10, v65
v_add_f32 v10, v10, v66
v_add_f32 v10, v10, v67
v_add_f32 v10, v10, v68
v_add_f32 v10, v10, v69
v_add_f32 v10, v10, v70
v_add_f32 v10, v10, v71
v_add_f32 v10, v10, v72
v_add_f32 v10, v10, v73
v_add_f32 v10, v10, v74
v_add_f32 v10, v10, v75
v_add_f32 v10, v10, v76
v_add_f32 v10, v10, v77
v_add_f32 v10, v10, v78
v_add_f32 v10, v10, v79
ds_read_b32 v64, v5 offset:32768
ds_read_b32 v65, v5 offset:33280
ds_read_b32 v66, v5 offset:33792
ds_read_b32 v67, v5 offset:34304
ds_read_b32 v68, v5 offset:34816
ds_read_b32 v69, v5 offset:35328
ds_read_b32 v70, v5 offset:35840
ds_read_b32 v71, v5 offset:36352
ds_read_b32 v72, v5 offset:36864
ds_read_b32 v73, v5 offset:37376
ds_read_b32 v74, v5 offset:37888
ds_read_b32 v75, v5 offset:38400
ds_read_b32 v76, v5 offset:38912
ds_read_b32 v77, v5 offset:39424
ds_read_b32 v78, v5 offset:39936
ds_read_b32 v79, v5 offset:40448
s_waitcnt lgkmcnt(0)
v_add_f32 v10, v10, v64
v_add_f32 v10, v10, v65
v_add_f32 v10, v10, v66
v_add_f32 v10, v10, v67
v_add_f32 v10, v10, v68
v_add_f32 v10, v10, v69
v_add_f32 v10, v10, v70
v_add_f32 v10, v10, v71
v_add_f32 v10, v10, v72
v_add_f32 v10, v10, v73
v_add_f32 v10, v10, v74
v_add_f32 v10, v10, v75
v_add_f32 v10, v10, v76
v_add_f32 v10, v10, v77
v_add_f32 v10, v10, v78
v_add_f32 v10, v10, v79
ds_read_b32 v64, v5 offset:40960
ds_read_b32 v65, v5 offset:41472
ds_read_b32 v66, v5 offset:41984
ds_read_b32 v67, v5 offset:42496
ds_read_b32 v68, v5 offset:43008
ds_read_b32 v69, v5 offset:43520
ds_read_b32 v70, v5 offset:44032
ds_read_b32 v71, v5 offset:44544
ds_read_b32 v72, v5 offset:45056
ds_read_b32 v73, v5 offset:45568
ds_read_b32 v74, v5 offset:46080
ds_read_b32 v75, v5 offset:46592
ds_read_b32 v76, v5 offset:47104
ds_read_b32 v77, v5 offset:47616
ds_read_b32 v78, v5 offset:48128
ds_read_b32 v79, v5 offset:48640
s_waitcnt lgkmcnt(0)
v_add_f32 v10, v10, v64
v_add_f32 v10, v10, v65
v_add_f32 v10, v10, v66
v_add_f32 v10, v10, v67
v_add_f32 v10, v10, v68
v_add_f32 v10, v10, v69
v_add_f32 v10, v10, v70
v_add_f32 v10, v10, v71
v_add_f32 v10, v10, v72
v_add_f32 v10, v10, v73
v_add_f32 v10, v10, v74
v_add_f32 v10, v10, v75
v_add_f32 v10, v10, v76
v_add_f32 v10, v10, v77
v_add_f32 v10, v10, v78
v_add_f32 v10, v10, v79
v_cvt_pk_bf16_f32 v10, v10, v10
v_lshrrev_b32 v2, 5, v0
v_and_b32 v1, 31, v0
v_lshlrev_b32 v2, 12, v2
v_add_u32 v2, v2, v1
s_lshl_b32 s25, s2, 5
v_add_u32 v2, s25, v2
v_lshlrev_b32 v2, 1, v2
s_mov_b32 s25, 65536
v_cmp_gt_u32 vcc, 128, v0
s_and_saveexec_b64 s[26:27], vcc
buffer_store_short v10, v2, s[20:23], s25 offen
k1_q_kernel_done:
s_endpgm
.globl k2_attn_kernel
.p2align 8
.type k2_attn_kernel,@function
k2_attn_kernel:
s_cmp_ge_u32 s2, 256
s_cbranch_scc1 k2_attn_kernel_done
s_load_dwordx2 s[4:5], s[0:1], 8
s_load_dwordx2 s[6:7], s[0:1], 16
s_load_dwordx2 s[8:9], s[0:1], 104
s_waitcnt lgkmcnt(0)
s_mov_b32 s12, s4
s_and_b32 s13, s5, 0xffff
s_mov_b32 s14, 134217728
s_mov_b32 s15, 0x00020000
s_mov_b32 s16, s6
s_and_b32 s17, s7, 0xffff
s_mov_b32 s18, 134217728
s_mov_b32 s19, 0x00020000
s_mov_b32 s20, s8
s_and_b32 s21, s9, 0xffff
s_mov_b32 s22, 536870912
s_mov_b32 s23, 0x00020000
v_and_b32 v1, 63, v0
v_lshrrev_b32 v2, 6, v0
v_and_b32 v3, 15, v1
v_lshrrev_b32 v4, 4, v1
v_lshlrev_b32 v5, 8, v3
v_lshl_add_u32 v5, v4, 4, v5
v_lshlrev_b32 v6, 10, v4
v_lshl_add_u32 v6, v3, 4, v6
s_lshl_b32 s24, s2, 19
v_readfirstlane_b32 s25, v2
s_lshl_b32 s25, s25, 12
s_add_u32 s24, s24, s25
s_lshr_b32 s26, s2, 1
s_lshl_b32 s26, s26, 8
s_add_u32 s26, s26, 65536
v_lshlrev_b32 v7, 4, v4
buffer_load_dwordx4 v[16:19], v7, s[20:23], s26 offen offset:0
buffer_load_dwordx4 v[20:23], v7, s[20:23], s26 offen offset:64
buffer_load_dwordx4 v[24:27], v7, s[20:23], s26 offen offset:128
buffer_load_dwordx4 v[28:31], v7, s[20:23], s26 offen offset:192
s_add_u32 s27, s24, 0
buffer_load_dwordx4 v[64:67], v5, s[12:15], s27 offen offset:0 nt
buffer_load_dwordx4 v[68:71], v5, s[12:15], s27 offen offset:64 nt
buffer_load_dwordx4 v[72:75], v5, s[12:15], s27 offen offset:128 nt
buffer_load_dwordx4 v[76:79], v5, s[12:15], s27 offen offset:192 nt
buffer_load_dwordx4 v[80:83], v6, s[16:19], s27 offen offset:0 nt
buffer_load_dwordx4 v[84:87], v6, s[16:19], s27 offen offset:256 nt
buffer_load_dwordx4 v[88:91], v6, s[16:19], s27 offen offset:512 nt
buffer_load_dwordx4 v[92:95], v6, s[16:19], s27 offen offset:768 nt
s_add_u32 s27, s24, 32768
buffer_load_dwordx4 v[96:99], v5, s[12:15], s27 offen offset:0 nt
buffer_load_dwordx4 v[100:103], v5, s[12:15], s27 offen offset:64 nt
buffer_load_dwordx4 v[104:107], v5, s[12:15], s27 offen offset:128 nt
buffer_load_dwordx4 v[108:111], v5, s[12:15], s27 offen offset:192 nt
buffer_load_dwordx4 v[112:115], v6, s[16:19], s27 offen offset:0 nt
buffer_load_dwordx4 v[116:119], v6, s[16:19], s27 offen offset:256 nt
buffer_load_dwordx4 v[120:123], v6, s[16:19], s27 offen offset:512 nt
buffer_load_dwordx4 v[124:127], v6, s[16:19], s27 offen offset:768 nt
s_add_u32 s27, s24, 65536
buffer_load_dwordx4 v[128:131], v5, s[12:15], s27 offen offset:0 nt
buffer_load_dwordx4 v[132:135], v5, s[12:15], s27 offen offset:64 nt
buffer_load_dwordx4 v[136:139], v5, s[12:15], s27 offen offset:128 nt
buffer_load_dwordx4 v[140:143], v5, s[12:15], s27 offen offset:192 nt
buffer_load_dwordx4 v[144:147], v6, s[16:19], s27 offen offset:0 nt
buffer_load_dwordx4 v[148:151], v6, s[16:19], s27 offen offset:256 nt
buffer_load_dwordx4 v[152:155], v6, s[16:19], s27 offen offset:512 nt
buffer_load_dwordx4 v[156:159], v6, s[16:19], s27 offen offset:768 nt
s_add_u32 s27, s24, 98304
buffer_load_dwordx4 v[160:163], v5, s[12:15], s27 offen offset:0 nt
buffer_load_dwordx4 v[164:167], v5, s[12:15], s27 offen offset:64 nt
buffer_load_dwordx4 v[168:171], v5, s[12:15], s27 offen offset:128 nt
buffer_load_dwordx4 v[172:175], v5, s[12:15], s27 offen offset:192 nt
buffer_load_dwordx4 v[176:179], v6, s[16:19], s27 offen offset:0 nt
buffer_load_dwordx4 v[180:183], v6, s[16:19], s27 offen offset:256 nt
buffer_load_dwordx4 v[184:187], v6, s[16:19], s27 offen offset:512 nt
buffer_load_dwordx4 v[188:191], v6, s[16:19], s27 offen offset:768 nt
v_mov_b32 v8, 0xff800000
v_mov_b32 v9, 0
v_mov_b32 v32, 0
v_mov_b32 v33, 0
v_mov_b32 v34, 0
v_mov_b32 v35, 0
v_mov_b32 v36, 0
v_mov_b32 v37, 0
v_mov_b32 v38, 0
v_mov_b32 v39, 0
s_mov_b32 s28, 0x3db504f3
s_mov_b32 s29, 0x3fb8aa3b
s_waitcnt vmcnt(28)
v_mfma_f32_16x16x32_bf16 v[40:43], v[64:67], v[16:19], 0
v_mfma_f32_16x16x32_bf16 v[40:43], v[68:71], v[20:23], v[40:43]
v_mfma_f32_16x16x32_bf16 v[40:43], v[72:75], v[24:27], v[40:43]
v_mfma_f32_16x16x32_bf16 v[40:43], v[76:79], v[28:31], v[40:43]
s_nop 7
s_nop 1
v_cvt_pk_bf16_f32 v40, v40, v40
v_and_b32 v40, 0xffff0000, v40
v_mul_f32 v40, s28, v40
v_cvt_pk_bf16_f32 v40, v40, v40
v_and_b32 v40, 0xffff0000, v40
v_cvt_pk_bf16_f32 v41, v41, v41
v_and_b32 v41, 0xffff0000, v41
v_mul_f32 v41, s28, v41
v_cvt_pk_bf16_f32 v41, v41, v41
v_and_b32 v41, 0xffff0000, v41
v_cvt_pk_bf16_f32 v42, v42, v42
v_and_b32 v42, 0xffff0000, v42
v_mul_f32 v42, s28, v42
v_cvt_pk_bf16_f32 v42, v42, v42
v_and_b32 v42, 0xffff0000, v42
v_cvt_pk_bf16_f32 v43, v43, v43
v_and_b32 v43, 0xffff0000, v43
v_mul_f32 v43, s28, v43
v_cvt_pk_bf16_f32 v43, v43, v43
v_and_b32 v43, 0xffff0000, v43
v_max3_f32 v44, v40, v41, v42
v_max3_f32 v44, v44, v43, v8
v_sub_f32 v45, v8, v44
v_mul_f32 v45, s29, v45
v_exp_f32 v45, v45
v_mov_b32 v8, v44
v_sub_f32 v40, v40, v44
v_mul_f32 v40, s29, v40
v_exp_f32 v40, v40
v_sub_f32 v41, v41, v44
v_mul_f32 v41, s29, v41
v_exp_f32 v41, v41
v_sub_f32 v42, v42, v44
v_mul_f32 v42, s29, v42
v_exp_f32 v42, v42
v_sub_f32 v43, v43, v44
v_mul_f32 v43, s29, v43
v_exp_f32 v43, v43
v_mul_f32 v9, v9, v45
v_mul_f32 v32, v32, v45
v_mul_f32 v33, v33, v45
v_mul_f32 v34, v34, v45
v_mul_f32 v35, v35, v45
v_mul_f32 v36, v36, v45
v_mul_f32 v37, v37, v45
v_mul_f32 v38, v38, v45
v_mul_f32 v39, v39, v45
v_add_f32 v9, v9, v40
v_add_f32 v9, v9, v41
v_add_f32 v9, v9, v42
v_add_f32 v9, v9, v43
s_waitcnt vmcnt(24)
v_lshlrev_b32 v46, 16, v80
v_and_b32 v47, 0xffff0000, v80
v_fmac_f32 v32, v40, v46
v_fmac_f32 v33, v40, v47
v_lshlrev_b32 v46, 16, v81
v_and_b32 v47, 0xffff0000, v81
v_fmac_f32 v34, v40, v46
v_fmac_f32 v35, v40, v47
v_lshlrev_b32 v46, 16, v82
v_and_b32 v47, 0xffff0000, v82
v_fmac_f32 v36, v40, v46
v_fmac_f32 v37, v40, v47
v_lshlrev_b32 v46, 16, v83
v_and_b32 v47, 0xffff0000, v83
v_fmac_f32 v38, v40, v46
v_fmac_f32 v39, v40, v47
v_lshlrev_b32 v46, 16, v84
v_and_b32 v47, 0xffff0000, v84
v_fmac_f32 v32, v41, v46
v_fmac_f32 v33, v41, v47
v_lshlrev_b32 v46, 16, v85
v_and_b32 v47, 0xffff0000, v85
v_fmac_f32 v34, v41, v46
v_fmac_f32 v35, v41, v47
v_lshlrev_b32 v46, 16, v86
v_and_b32 v47, 0xffff0000, v86
v_fmac_f32 v36, v41, v46
v_fmac_f32 v37, v41, v47
v_lshlrev_b32 v46, 16, v87
v_and_b32 v47, 0xffff0000, v87
v_fmac_f32 v38, v41, v46
v_fmac_f32 v39, v41, v47
v_lshlrev_b32 v46, 16, v88
v_and_b32 v47, 0xffff0000, v88
v_fmac_f32 v32, v42, v46
v_fmac_f32 v33, v42, v47
v_lshlrev_b32 v46, 16, v89
v_and_b32 v47, 0xffff0000, v89
v_fmac_f32 v34, v42, v46
v_fmac_f32 v35, v42, v47
v_lshlrev_b32 v46, 16, v90
v_and_b32 v47, 0xffff0000, v90
v_fmac_f32 v36, v42, v46
v_fmac_f32 v37, v42, v47
v_lshlrev_b32 v46, 16, v91
v_and_b32 v47, 0xffff0000, v91
v_fmac_f32 v38, v42, v46
v_fmac_f32 v39, v42, v47
v_lshlrev_b32 v46, 16, v92
v_and_b32 v47, 0xffff0000, v92
v_fmac_f32 v32, v43, v46
v_fmac_f32 v33, v43, v47
v_lshlrev_b32 v46, 16, v93
v_and_b32 v47, 0xffff0000, v93
v_fmac_f32 v34, v43, v46
v_fmac_f32 v35, v43, v47
v_lshlrev_b32 v46, 16, v94
v_and_b32 v47, 0xffff0000, v94
v_fmac_f32 v36, v43, v46
v_fmac_f32 v37, v43, v47
v_lshlrev_b32 v46, 16, v95
v_and_b32 v47, 0xffff0000, v95
v_fmac_f32 v38, v43, v46
v_fmac_f32 v39, v43, v47
s_add_u32 s27, s24, 131072
buffer_load_dwordx4 v[64:67], v5, s[12:15], s27 offen offset:0 nt
buffer_load_dwordx4 v[68:71], v5, s[12:15], s27 offen offset:64 nt
buffer_load_dwordx4 v[72:75], v5, s[12:15], s27 offen offset:128 nt
buffer_load_dwordx4 v[76:79], v5, s[12:15], s27 offen offset:192 nt
buffer_load_dwordx4 v[80:83], v6, s[16:19], s27 offen offset:0 nt
buffer_load_dwordx4 v[84:87], v6, s[16:19], s27 offen offset:256 nt
buffer_load_dwordx4 v[88:91], v6, s[16:19], s27 offen offset:512 nt
buffer_load_dwordx4 v[92:95], v6, s[16:19], s27 offen offset:768 nt
s_waitcnt vmcnt(28)
v_mfma_f32_16x16x32_bf16 v[40:43], v[96:99], v[16:19], 0
v_mfma_f32_16x16x32_bf16 v[40:43], v[100:103], v[20:23], v[40:43]
v_mfma_f32_16x16x32_bf16 v[40:43], v[104:107], v[24:27], v[40:43]
v_mfma_f32_16x16x32_bf16 v[40:43], v[108:111], v[28:31], v[40:43]
s_nop 7
s_nop 1
v_cvt_pk_bf16_f32 v40, v40, v40
v_and_b32 v40, 0xffff0000, v40
v_mul_f32 v40, s28, v40
v_cvt_pk_bf16_f32 v40, v40, v40
v_and_b32 v40, 0xffff0000, v40
v_cvt_pk_bf16_f32 v41, v41, v41
v_and_b32 v41, 0xffff0000, v41
v_mul_f32 v41, s28, v41
v_cvt_pk_bf16_f32 v41, v41, v41
v_and_b32 v41, 0xffff0000, v41
v_cvt_pk_bf16_f32 v42, v42, v42
v_and_b32 v42, 0xffff0000, v42
v_mul_f32 v42, s28, v42
v_cvt_pk_bf16_f32 v42, v42, v42
v_and_b32 v42, 0xffff0000, v42
v_cvt_pk_bf16_f32 v43, v43, v43
v_and_b32 v43, 0xffff0000, v43
v_mul_f32 v43, s28, v43
v_cvt_pk_bf16_f32 v43, v43, v43
v_and_b32 v43, 0xffff0000, v43
v_max3_f32 v44, v40, v41, v42
v_max3_f32 v44, v44, v43, v8
v_sub_f32 v45, v8, v44
v_mul_f32 v45, s29, v45
v_exp_f32 v45, v45
v_mov_b32 v8, v44
v_sub_f32 v40, v40, v44
v_mul_f32 v40, s29, v40
v_exp_f32 v40, v40
v_sub_f32 v41, v41, v44
v_mul_f32 v41, s29, v41
v_exp_f32 v41, v41
v_sub_f32 v42, v42, v44
v_mul_f32 v42, s29, v42
v_exp_f32 v42, v42
v_sub_f32 v43, v43, v44
v_mul_f32 v43, s29, v43
v_exp_f32 v43, v43
v_mul_f32 v9, v9, v45
v_mul_f32 v32, v32, v45
v_mul_f32 v33, v33, v45
v_mul_f32 v34, v34, v45
v_mul_f32 v35, v35, v45
v_mul_f32 v36, v36, v45
v_mul_f32 v37, v37, v45
v_mul_f32 v38, v38, v45
v_mul_f32 v39, v39, v45
v_add_f32 v9, v9, v40
v_add_f32 v9, v9, v41
v_add_f32 v9, v9, v42
v_add_f32 v9, v9, v43
s_waitcnt vmcnt(24)
v_lshlrev_b32 v46, 16, v112
v_and_b32 v47, 0xffff0000, v112
v_fmac_f32 v32, v40, v46
v_fmac_f32 v33, v40, v47
v_lshlrev_b32 v46, 16, v113
v_and_b32 v47, 0xffff0000, v113
v_fmac_f32 v34, v40, v46
v_fmac_f32 v35, v40, v47
v_lshlrev_b32 v46, 16, v114
v_and_b32 v47, 0xffff0000, v114
v_fmac_f32 v36, v40, v46
v_fmac_f32 v37, v40, v47
v_lshlrev_b32 v46, 16, v115
v_and_b32 v47, 0xffff0000, v115
v_fmac_f32 v38, v40, v46
v_fmac_f32 v39, v40, v47
v_lshlrev_b32 v46, 16, v116
v_and_b32 v47, 0xffff0000, v116
v_fmac_f32 v32, v41, v46
v_fmac_f32 v33, v41, v47
v_lshlrev_b32 v46, 16, v117
v_and_b32 v47, 0xffff0000, v117
v_fmac_f32 v34, v41, v46
v_fmac_f32 v35, v41, v47
v_lshlrev_b32 v46, 16, v118
v_and_b32 v47, 0xffff0000, v118
v_fmac_f32 v36, v41, v46
v_fmac_f32 v37, v41, v47
v_lshlrev_b32 v46, 16, v119
v_and_b32 v47, 0xffff0000, v119
v_fmac_f32 v38, v41, v46
v_fmac_f32 v39, v41, v47
v_lshlrev_b32 v46, 16, v120
v_and_b32 v47, 0xffff0000, v120
v_fmac_f32 v32, v42, v46
v_fmac_f32 v33, v42, v47
v_lshlrev_b32 v46, 16, v121
v_and_b32 v47, 0xffff0000, v121
v_fmac_f32 v34, v42, v46
v_fmac_f32 v35, v42, v47
v_lshlrev_b32 v46, 16, v122
v_and_b32 v47, 0xffff0000, v122
v_fmac_f32 v36, v42, v46
v_fmac_f32 v37, v42, v47
v_lshlrev_b32 v46, 16, v123
v_and_b32 v47, 0xffff0000, v123
v_fmac_f32 v38, v42, v46
v_fmac_f32 v39, v42, v47
v_lshlrev_b32 v46, 16, v124
v_and_b32 v47, 0xffff0000, v124
v_fmac_f32 v32, v43, v46
v_fmac_f32 v33, v43, v47
v_lshlrev_b32 v46, 16, v125
v_and_b32 v47, 0xffff0000, v125
v_fmac_f32 v34, v43, v46
v_fmac_f32 v35, v43, v47
v_lshlrev_b32 v46, 16, v126
v_and_b32 v47, 0xffff0000, v126
v_fmac_f32 v36, v43, v46
v_fmac_f32 v37, v43, v47
v_lshlrev_b32 v46, 16, v127
v_and_b32 v47, 0xffff0000, v127
v_fmac_f32 v38, v43, v46
v_fmac_f32 v39, v43, v47
s_add_u32 s27, s24, 163840
buffer_load_dwordx4 v[96:99], v5, s[12:15], s27 offen offset:0 nt
buffer_load_dwordx4 v[100:103], v5, s[12:15], s27 offen offset:64 nt
buffer_load_dwordx4 v[104:107], v5, s[12:15], s27 offen offset:128 nt
buffer_load_dwordx4 v[108:111], v5, s[12:15], s27 offen offset:192 nt
buffer_load_dwordx4 v[112:115], v6, s[16:19], s27 offen offset:0 nt
buffer_load_dwordx4 v[116:119], v6, s[16:19], s27 offen offset:256 nt
buffer_load_dwordx4 v[120:123], v6, s[16:19], s27 offen offset:512 nt
buffer_load_dwordx4 v[124:127], v6, s[16:19], s27 offen offset:768 nt
s_waitcnt vmcnt(28)
v_mfma_f32_16x16x32_bf16 v[40:43], v[128:131], v[16:19], 0
v_mfma_f32_16x16x32_bf16 v[40:43], v[132:135], v[20:23], v[40:43]
v_mfma_f32_16x16x32_bf16 v[40:43], v[136:139], v[24:27], v[40:43]
v_mfma_f32_16x16x32_bf16 v[40:43], v[140:143], v[28:31], v[40:43]
s_nop 7
s_nop 1
v_cvt_pk_bf16_f32 v40, v40, v40
v_and_b32 v40, 0xffff0000, v40
v_mul_f32 v40, s28, v40
v_cvt_pk_bf16_f32 v40, v40, v40
v_and_b32 v40, 0xffff0000, v40
v_cvt_pk_bf16_f32 v41, v41, v41
v_and_b32 v41, 0xffff0000, v41
v_mul_f32 v41, s28, v41
v_cvt_pk_bf16_f32 v41, v41, v41
v_and_b32 v41, 0xffff0000, v41
v_cvt_pk_bf16_f32 v42, v42, v42
v_and_b32 v42, 0xffff0000, v42
v_mul_f32 v42, s28, v42
v_cvt_pk_bf16_f32 v42, v42, v42
v_and_b32 v42, 0xffff0000, v42
v_cvt_pk_bf16_f32 v43, v43, v43
v_and_b32 v43, 0xffff0000, v43
v_mul_f32 v43, s28, v43
v_cvt_pk_bf16_f32 v43, v43, v43
v_and_b32 v43, 0xffff0000, v43
v_max3_f32 v44, v40, v41, v42
v_max3_f32 v44, v44, v43, v8
v_sub_f32 v45, v8, v44
v_mul_f32 v45, s29, v45
v_exp_f32 v45, v45
v_mov_b32 v8, v44
v_sub_f32 v40, v40, v44
v_mul_f32 v40, s29, v40
v_exp_f32 v40, v40
v_sub_f32 v41, v41, v44
v_mul_f32 v41, s29, v41
v_exp_f32 v41, v41
v_sub_f32 v42, v42, v44
v_mul_f32 v42, s29, v42
v_exp_f32 v42, v42
v_sub_f32 v43, v43, v44
v_mul_f32 v43, s29, v43
v_exp_f32 v43, v43
v_mul_f32 v9, v9, v45
v_mul_f32 v32, v32, v45
v_mul_f32 v33, v33, v45
v_mul_f32 v34, v34, v45
v_mul_f32 v35, v35, v45
v_mul_f32 v36, v36, v45
v_mul_f32 v37, v37, v45
v_mul_f32 v38, v38, v45
v_mul_f32 v39, v39, v45
v_add_f32 v9, v9, v40
v_add_f32 v9, v9, v41
v_add_f32 v9, v9, v42
v_add_f32 v9, v9, v43
s_waitcnt vmcnt(24)
v_lshlrev_b32 v46, 16, v144
v_and_b32 v47, 0xffff0000, v144
v_fmac_f32 v32, v40, v46
v_fmac_f32 v33, v40, v47
v_lshlrev_b32 v46, 16, v145
v_and_b32 v47, 0xffff0000, v145
v_fmac_f32 v34, v40, v46
v_fmac_f32 v35, v40, v47
v_lshlrev_b32 v46, 16, v146
v_and_b32 v47, 0xffff0000, v146
v_fmac_f32 v36, v40, v46
v_fmac_f32 v37, v40, v47
v_lshlrev_b32 v46, 16, v147
v_and_b32 v47, 0xffff0000, v147
v_fmac_f32 v38, v40, v46
v_fmac_f32 v39, v40, v47
v_lshlrev_b32 v46, 16, v148
v_and_b32 v47, 0xffff0000, v148
v_fmac_f32 v32, v41, v46
v_fmac_f32 v33, v41, v47
v_lshlrev_b32 v46, 16, v149
v_and_b32 v47, 0xffff0000, v149
v_fmac_f32 v34, v41, v46
v_fmac_f32 v35, v41, v47
v_lshlrev_b32 v46, 16, v150
v_and_b32 v47, 0xffff0000, v150
v_fmac_f32 v36, v41, v46
v_fmac_f32 v37, v41, v47
v_lshlrev_b32 v46, 16, v151
v_and_b32 v47, 0xffff0000, v151
v_fmac_f32 v38, v41, v46
v_fmac_f32 v39, v41, v47
v_lshlrev_b32 v46, 16, v152
v_and_b32 v47, 0xffff0000, v152
v_fmac_f32 v32, v42, v46
v_fmac_f32 v33, v42, v47
v_lshlrev_b32 v46, 16, v153
v_and_b32 v47, 0xffff0000, v153
v_fmac_f32 v34, v42, v46
v_fmac_f32 v35, v42, v47
v_lshlrev_b32 v46, 16, v154
v_and_b32 v47, 0xffff0000, v154
v_fmac_f32 v36, v42, v46
v_fmac_f32 v37, v42, v47
v_lshlrev_b32 v46, 16, v155
v_and_b32 v47, 0xffff0000, v155
v_fmac_f32 v38, v42, v46
v_fmac_f32 v39, v42, v47
v_lshlrev_b32 v46, 16, v156
v_and_b32 v47, 0xffff0000, v156
v_fmac_f32 v32, v43, v46
v_fmac_f32 v33, v43, v47
v_lshlrev_b32 v46, 16, v157
v_and_b32 v47, 0xffff0000, v157
v_fmac_f32 v34, v43, v46
v_fmac_f32 v35, v43, v47
v_lshlrev_b32 v46, 16, v158
v_and_b32 v47, 0xffff0000, v158
v_fmac_f32 v36, v43, v46
v_fmac_f32 v37, v43, v47
v_lshlrev_b32 v46, 16, v159
v_and_b32 v47, 0xffff0000, v159
v_fmac_f32 v38, v43, v46
v_fmac_f32 v39, v43, v47
s_add_u32 s27, s24, 196608
buffer_load_dwordx4 v[128:131], v5, s[12:15], s27 offen offset:0 nt
buffer_load_dwordx4 v[132:135], v5, s[12:15], s27 offen offset:64 nt
buffer_load_dwordx4 v[136:139], v5, s[12:15], s27 offen offset:128 nt
buffer_load_dwordx4 v[140:143], v5, s[12:15], s27 offen offset:192 nt
buffer_load_dwordx4 v[144:147], v6, s[16:19], s27 offen offset:0 nt
buffer_load_dwordx4 v[148:151], v6, s[16:19], s27 offen offset:256 nt
buffer_load_dwordx4 v[152:155], v6, s[16:19], s27 offen offset:512 nt
buffer_load_dwordx4 v[156:159], v6, s[16:19], s27 offen offset:768 nt
s_waitcnt vmcnt(28)
v_mfma_f32_16x16x32_bf16 v[40:43], v[160:163], v[16:19], 0
v_mfma_f32_16x16x32_bf16 v[40:43], v[164:167], v[20:23], v[40:43]
v_mfma_f32_16x16x32_bf16 v[40:43], v[168:171], v[24:27], v[40:43]
v_mfma_f32_16x16x32_bf16 v[40:43], v[172:175], v[28:31], v[40:43]
s_nop 7
s_nop 1
v_cvt_pk_bf16_f32 v40, v40, v40
v_and_b32 v40, 0xffff0000, v40
v_mul_f32 v40, s28, v40
v_cvt_pk_bf16_f32 v40, v40, v40
v_and_b32 v40, 0xffff0000, v40
v_cvt_pk_bf16_f32 v41, v41, v41
v_and_b32 v41, 0xffff0000, v41
v_mul_f32 v41, s28, v41
v_cvt_pk_bf16_f32 v41, v41, v41
v_and_b32 v41, 0xffff0000, v41
v_cvt_pk_bf16_f32 v42, v42, v42
v_and_b32 v42, 0xffff0000, v42
v_mul_f32 v42, s28, v42
v_cvt_pk_bf16_f32 v42, v42, v42
v_and_b32 v42, 0xffff0000, v42
v_cvt_pk_bf16_f32 v43, v43, v43
v_and_b32 v43, 0xffff0000, v43
v_mul_f32 v43, s28, v43
v_cvt_pk_bf16_f32 v43, v43, v43
v_and_b32 v43, 0xffff0000, v43
v_max3_f32 v44, v40, v41, v42
v_max3_f32 v44, v44, v43, v8
v_sub_f32 v45, v8, v44
v_mul_f32 v45, s29, v45
v_exp_f32 v45, v45
v_mov_b32 v8, v44
v_sub_f32 v40, v40, v44
v_mul_f32 v40, s29, v40
v_exp_f32 v40, v40
v_sub_f32 v41, v41, v44
v_mul_f32 v41, s29, v41
v_exp_f32 v41, v41
v_sub_f32 v42, v42, v44
v_mul_f32 v42, s29, v42
v_exp_f32 v42, v42
v_sub_f32 v43, v43, v44
v_mul_f32 v43, s29, v43
v_exp_f32 v43, v43
v_mul_f32 v9, v9, v45
v_mul_f32 v32, v32, v45
v_mul_f32 v33, v33, v45
v_mul_f32 v34, v34, v45
v_mul_f32 v35, v35, v45
v_mul_f32 v36, v36, v45
v_mul_f32 v37, v37, v45
v_mul_f32 v38, v38, v45
v_mul_f32 v39, v39, v45
v_add_f32 v9, v9, v40
v_add_f32 v9, v9, v41
v_add_f32 v9, v9, v42
v_add_f32 v9, v9, v43
s_waitcnt vmcnt(24)
v_lshlrev_b32 v46, 16, v176
v_and_b32 v47, 0xffff0000, v176
v_fmac_f32 v32, v40, v46
v_fmac_f32 v33, v40, v47
v_lshlrev_b32 v46, 16, v177
v_and_b32 v47, 0xffff0000, v177
v_fmac_f32 v34, v40, v46
v_fmac_f32 v35, v40, v47
v_lshlrev_b32 v46, 16, v178
v_and_b32 v47, 0xffff0000, v178
v_fmac_f32 v36, v40, v46
v_fmac_f32 v37, v40, v47
v_lshlrev_b32 v46, 16, v179
v_and_b32 v47, 0xffff0000, v179
v_fmac_f32 v38, v40, v46
v_fmac_f32 v39, v40, v47
v_lshlrev_b32 v46, 16, v180
v_and_b32 v47, 0xffff0000, v180
v_fmac_f32 v32, v41, v46
v_fmac_f32 v33, v41, v47
v_lshlrev_b32 v46, 16, v181
v_and_b32 v47, 0xffff0000, v181
v_fmac_f32 v34, v41, v46
v_fmac_f32 v35, v41, v47
v_lshlrev_b32 v46, 16, v182
v_and_b32 v47, 0xffff0000, v182
v_fmac_f32 v36, v41, v46
v_fmac_f32 v37, v41, v47
v_lshlrev_b32 v46, 16, v183
v_and_b32 v47, 0xffff0000, v183
v_fmac_f32 v38, v41, v46
v_fmac_f32 v39, v41, v47
v_lshlrev_b32 v46, 16, v184
v_and_b32 v47, 0xffff0000, v184
v_fmac_f32 v32, v42, v46
v_fmac_f32 v33, v42, v47
v_lshlrev_b32 v46, 16, v185
v_and_b32 v47, 0xffff0000, v185
v_fmac_f32 v34, v42, v46
v_fmac_f32 v35, v42, v47
v_lshlrev_b32 v46, 16, v186
v_and_b32 v47, 0xffff0000, v186
v_fmac_f32 v36, v42, v46
v_fmac_f32 v37, v42, v47
v_lshlrev_b32 v46, 16, v187
v_and_b32 v47, 0xffff0000, v187
v_fmac_f32 v38, v42, v46
v_fmac_f32 v39, v42, v47
v_lshlrev_b32 v46, 16, v188
v_and_b32 v47, 0xffff0000, v188
v_fmac_f32 v32, v43, v46
v_fmac_f32 v33, v43, v47
v_lshlrev_b32 v46, 16, v189
v_and_b32 v47, 0xffff0000, v189
v_fmac_f32 v34, v43, v46
v_fmac_f32 v35, v43, v47
v_lshlrev_b32 v46, 16, v190
v_and_b32 v47, 0xffff0000, v190
v_fmac_f32 v36, v43, v46
v_fmac_f32 v37, v43, v47
v_lshlrev_b32 v46, 16, v191
v_and_b32 v47, 0xffff0000, v191
v_fmac_f32 v38, v43, v46
v_fmac_f32 v39, v43, v47
s_add_u32 s27, s24, 229376
buffer_load_dwordx4 v[160:163], v5, s[12:15], s27 offen offset:0 nt
buffer_load_dwordx4 v[164:167], v5, s[12:15], s27 offen offset:64 nt
buffer_load_dwordx4 v[168:171], v5, s[12:15], s27 offen offset:128 nt
buffer_load_dwordx4 v[172:175], v5, s[12:15], s27 offen offset:192 nt
buffer_load_dwordx4 v[176:179], v6, s[16:19], s27 offen offset:0 nt
buffer_load_dwordx4 v[180:183], v6, s[16:19], s27 offen offset:256 nt
buffer_load_dwordx4 v[184:187], v6, s[16:19], s27 offen offset:512 nt
buffer_load_dwordx4 v[188:191], v6, s[16:19], s27 offen offset:768 nt
s_waitcnt vmcnt(28)
v_mfma_f32_16x16x32_bf16 v[40:43], v[64:67], v[16:19], 0
v_mfma_f32_16x16x32_bf16 v[40:43], v[68:71], v[20:23], v[40:43]
v_mfma_f32_16x16x32_bf16 v[40:43], v[72:75], v[24:27], v[40:43]
v_mfma_f32_16x16x32_bf16 v[40:43], v[76:79], v[28:31], v[40:43]
s_nop 7
s_nop 1
v_cvt_pk_bf16_f32 v40, v40, v40
v_and_b32 v40, 0xffff0000, v40
v_mul_f32 v40, s28, v40
v_cvt_pk_bf16_f32 v40, v40, v40
v_and_b32 v40, 0xffff0000, v40
v_cvt_pk_bf16_f32 v41, v41, v41
v_and_b32 v41, 0xffff0000, v41
v_mul_f32 v41, s28, v41
v_cvt_pk_bf16_f32 v41, v41, v41
v_and_b32 v41, 0xffff0000, v41
v_cvt_pk_bf16_f32 v42, v42, v42
v_and_b32 v42, 0xffff0000, v42
v_mul_f32 v42, s28, v42
v_cvt_pk_bf16_f32 v42, v42, v42
v_and_b32 v42, 0xffff0000, v42
v_cvt_pk_bf16_f32 v43, v43, v43
v_and_b32 v43, 0xffff0000, v43
v_mul_f32 v43, s28, v43
v_cvt_pk_bf16_f32 v43, v43, v43
v_and_b32 v43, 0xffff0000, v43
v_max3_f32 v44, v40, v41, v42
v_max3_f32 v44, v44, v43, v8
v_sub_f32 v45, v8, v44
v_mul_f32 v45, s29, v45
v_exp_f32 v45, v45
v_mov_b32 v8, v44
v_sub_f32 v40, v40, v44
v_mul_f32 v40, s29, v40
v_exp_f32 v40, v40
v_sub_f32 v41, v41, v44
v_mul_f32 v41, s29, v41
v_exp_f32 v41, v41
v_sub_f32 v42, v42, v44
v_mul_f32 v42, s29, v42
v_exp_f32 v42, v42
v_sub_f32 v43, v43, v44
v_mul_f32 v43, s29, v43
v_exp_f32 v43, v43
v_mul_f32 v9, v9, v45
v_mul_f32 v32, v32, v45
v_mul_f32 v33, v33, v45
v_mul_f32 v34, v34, v45
v_mul_f32 v35, v35, v45
v_mul_f32 v36, v36, v45
v_mul_f32 v37, v37, v45
v_mul_f32 v38, v38, v45
v_mul_f32 v39, v39, v45
v_add_f32 v9, v9, v40
v_add_f32 v9, v9, v41
v_add_f32 v9, v9, v42
v_add_f32 v9, v9, v43
s_waitcnt vmcnt(24)
v_lshlrev_b32 v46, 16, v80
v_and_b32 v47, 0xffff0000, v80
v_fmac_f32 v32, v40, v46
v_fmac_f32 v33, v40, v47
v_lshlrev_b32 v46, 16, v81
v_and_b32 v47, 0xffff0000, v81
v_fmac_f32 v34, v40, v46
v_fmac_f32 v35, v40, v47
v_lshlrev_b32 v46, 16, v82
v_and_b32 v47, 0xffff0000, v82
v_fmac_f32 v36, v40, v46
v_fmac_f32 v37, v40, v47
v_lshlrev_b32 v46, 16, v83
v_and_b32 v47, 0xffff0000, v83
v_fmac_f32 v38, v40, v46
v_fmac_f32 v39, v40, v47
v_lshlrev_b32 v46, 16, v84
v_and_b32 v47, 0xffff0000, v84
v_fmac_f32 v32, v41, v46
v_fmac_f32 v33, v41, v47
v_lshlrev_b32 v46, 16, v85
v_and_b32 v47, 0xffff0000, v85
v_fmac_f32 v34, v41, v46
v_fmac_f32 v35, v41, v47
v_lshlrev_b32 v46, 16, v86
v_and_b32 v47, 0xffff0000, v86
v_fmac_f32 v36, v41, v46
v_fmac_f32 v37, v41, v47
v_lshlrev_b32 v46, 16, v87
v_and_b32 v47, 0xffff0000, v87
v_fmac_f32 v38, v41, v46
v_fmac_f32 v39, v41, v47
v_lshlrev_b32 v46, 16, v88
v_and_b32 v47, 0xffff0000, v88
v_fmac_f32 v32, v42, v46
v_fmac_f32 v33, v42, v47
v_lshlrev_b32 v46, 16, v89
v_and_b32 v47, 0xffff0000, v89
v_fmac_f32 v34, v42, v46
v_fmac_f32 v35, v42, v47
v_lshlrev_b32 v46, 16, v90
v_and_b32 v47, 0xffff0000, v90
v_fmac_f32 v36, v42, v46
v_fmac_f32 v37, v42, v47
v_lshlrev_b32 v46, 16, v91
v_and_b32 v47, 0xffff0000, v91
v_fmac_f32 v38, v42, v46
v_fmac_f32 v39, v42, v47
v_lshlrev_b32 v46, 16, v92
v_and_b32 v47, 0xffff0000, v92
v_fmac_f32 v32, v43, v46
v_fmac_f32 v33, v43, v47
v_lshlrev_b32 v46, 16, v93
v_and_b32 v47, 0xffff0000, v93
v_fmac_f32 v34, v43, v46
v_fmac_f32 v35, v43, v47
v_lshlrev_b32 v46, 16, v94
v_and_b32 v47, 0xffff0000, v94
v_fmac_f32 v36, v43, v46
v_fmac_f32 v37, v43, v47
v_lshlrev_b32 v46, 16, v95
v_and_b32 v47, 0xffff0000, v95
v_fmac_f32 v38, v43, v46
v_fmac_f32 v39, v43, v47
s_add_u32 s27, s24, 262144
buffer_load_dwordx4 v[64:67], v5, s[12:15], s27 offen offset:0 nt
buffer_load_dwordx4 v[68:71], v5, s[12:15], s27 offen offset:64 nt
buffer_load_dwordx4 v[72:75], v5, s[12:15], s27 offen offset:128 nt
buffer_load_dwordx4 v[76:79], v5, s[12:15], s27 offen offset:192 nt
buffer_load_dwordx4 v[80:83], v6, s[16:19], s27 offen offset:0 nt
buffer_load_dwordx4 v[84:87], v6, s[16:19], s27 offen offset:256 nt
buffer_load_dwordx4 v[88:91], v6, s[16:19], s27 offen offset:512 nt
buffer_load_dwordx4 v[92:95], v6, s[16:19], s27 offen offset:768 nt
s_waitcnt vmcnt(28)
v_mfma_f32_16x16x32_bf16 v[40:43], v[96:99], v[16:19], 0
v_mfma_f32_16x16x32_bf16 v[40:43], v[100:103], v[20:23], v[40:43]
v_mfma_f32_16x16x32_bf16 v[40:43], v[104:107], v[24:27], v[40:43]
v_mfma_f32_16x16x32_bf16 v[40:43], v[108:111], v[28:31], v[40:43]
s_nop 7
s_nop 1
v_cvt_pk_bf16_f32 v40, v40, v40
v_and_b32 v40, 0xffff0000, v40
v_mul_f32 v40, s28, v40
v_cvt_pk_bf16_f32 v40, v40, v40
v_and_b32 v40, 0xffff0000, v40
v_cvt_pk_bf16_f32 v41, v41, v41
v_and_b32 v41, 0xffff0000, v41
v_mul_f32 v41, s28, v41
v_cvt_pk_bf16_f32 v41, v41, v41
v_and_b32 v41, 0xffff0000, v41
v_cvt_pk_bf16_f32 v42, v42, v42
v_and_b32 v42, 0xffff0000, v42
v_mul_f32 v42, s28, v42
v_cvt_pk_bf16_f32 v42, v42, v42
v_and_b32 v42, 0xffff0000, v42
v_cvt_pk_bf16_f32 v43, v43, v43
v_and_b32 v43, 0xffff0000, v43
v_mul_f32 v43, s28, v43
v_cvt_pk_bf16_f32 v43, v43, v43
v_and_b32 v43, 0xffff0000, v43
v_max3_f32 v44, v40, v41, v42
v_max3_f32 v44, v44, v43, v8
v_sub_f32 v45, v8, v44
v_mul_f32 v45, s29, v45
v_exp_f32 v45, v45
v_mov_b32 v8, v44
v_sub_f32 v40, v40, v44
v_mul_f32 v40, s29, v40
v_exp_f32 v40, v40
v_sub_f32 v41, v41, v44
v_mul_f32 v41, s29, v41
v_exp_f32 v41, v41
v_sub_f32 v42, v42, v44
v_mul_f32 v42, s29, v42
v_exp_f32 v42, v42
v_sub_f32 v43, v43, v44
v_mul_f32 v43, s29, v43
v_exp_f32 v43, v43
v_mul_f32 v9, v9, v45
v_mul_f32 v32, v32, v45
v_mul_f32 v33, v33, v45
v_mul_f32 v34, v34, v45
v_mul_f32 v35, v35, v45
v_mul_f32 v36, v36, v45
v_mul_f32 v37, v37, v45
v_mul_f32 v38, v38, v45
v_mul_f32 v39, v39, v45
v_add_f32 v9, v9, v40
v_add_f32 v9, v9, v41
v_add_f32 v9, v9, v42
v_add_f32 v9, v9, v43
s_waitcnt vmcnt(24)
v_lshlrev_b32 v46, 16, v112
v_and_b32 v47, 0xffff0000, v112
v_fmac_f32 v32, v40, v46
v_fmac_f32 v33, v40, v47
v_lshlrev_b32 v46, 16, v113
v_and_b32 v47, 0xffff0000, v113
v_fmac_f32 v34, v40, v46
v_fmac_f32 v35, v40, v47
v_lshlrev_b32 v46, 16, v114
v_and_b32 v47, 0xffff0000, v114
v_fmac_f32 v36, v40, v46
v_fmac_f32 v37, v40, v47
v_lshlrev_b32 v46, 16, v115
v_and_b32 v47, 0xffff0000, v115
v_fmac_f32 v38, v40, v46
v_fmac_f32 v39, v40, v47
v_lshlrev_b32 v46, 16, v116
v_and_b32 v47, 0xffff0000, v116
v_fmac_f32 v32, v41, v46
v_fmac_f32 v33, v41, v47
v_lshlrev_b32 v46, 16, v117
v_and_b32 v47, 0xffff0000, v117
v_fmac_f32 v34, v41, v46
v_fmac_f32 v35, v41, v47
v_lshlrev_b32 v46, 16, v118
v_and_b32 v47, 0xffff0000, v118
v_fmac_f32 v36, v41, v46
v_fmac_f32 v37, v41, v47
v_lshlrev_b32 v46, 16, v119
v_and_b32 v47, 0xffff0000, v119
v_fmac_f32 v38, v41, v46
v_fmac_f32 v39, v41, v47
v_lshlrev_b32 v46, 16, v120
v_and_b32 v47, 0xffff0000, v120
v_fmac_f32 v32, v42, v46
v_fmac_f32 v33, v42, v47
v_lshlrev_b32 v46, 16, v121
v_and_b32 v47, 0xffff0000, v121
v_fmac_f32 v34, v42, v46
v_fmac_f32 v35, v42, v47
v_lshlrev_b32 v46, 16, v122
v_and_b32 v47, 0xffff0000, v122
v_fmac_f32 v36, v42, v46
v_fmac_f32 v37, v42, v47
v_lshlrev_b32 v46, 16, v123
v_and_b32 v47, 0xffff0000, v123
v_fmac_f32 v38, v42, v46
v_fmac_f32 v39, v42, v47
v_lshlrev_b32 v46, 16, v124
v_and_b32 v47, 0xffff0000, v124
v_fmac_f32 v32, v43, v46
v_fmac_f32 v33, v43, v47
v_lshlrev_b32 v46, 16, v125
v_and_b32 v47, 0xffff0000, v125
v_fmac_f32 v34, v43, v46
v_fmac_f32 v35, v43, v47
v_lshlrev_b32 v46, 16, v126
v_and_b32 v47, 0xffff0000, v126
v_fmac_f32 v36, v43, v46
v_fmac_f32 v37, v43, v47
v_lshlrev_b32 v46, 16, v127
v_and_b32 v47, 0xffff0000, v127
v_fmac_f32 v38, v43, v46
v_fmac_f32 v39, v43, v47
s_add_u32 s27, s24, 294912
buffer_load_dwordx4 v[96:99], v5, s[12:15], s27 offen offset:0 nt
buffer_load_dwordx4 v[100:103], v5, s[12:15], s27 offen offset:64 nt
buffer_load_dwordx4 v[104:107], v5, s[12:15], s27 offen offset:128 nt
buffer_load_dwordx4 v[108:111], v5, s[12:15], s27 offen offset:192 nt
buffer_load_dwordx4 v[112:115], v6, s[16:19], s27 offen offset:0 nt
buffer_load_dwordx4 v[116:119], v6, s[16:19], s27 offen offset:256 nt
buffer_load_dwordx4 v[120:123], v6, s[16:19], s27 offen offset:512 nt
buffer_load_dwordx4 v[124:127], v6, s[16:19], s27 offen offset:768 nt
s_waitcnt vmcnt(28)
v_mfma_f32_16x16x32_bf16 v[40:43], v[128:131], v[16:19], 0
v_mfma_f32_16x16x32_bf16 v[40:43], v[132:135], v[20:23], v[40:43]
v_mfma_f32_16x16x32_bf16 v[40:43], v[136:139], v[24:27], v[40:43]
v_mfma_f32_16x16x32_bf16 v[40:43], v[140:143], v[28:31], v[40:43]
s_nop 7
s_nop 1
v_cvt_pk_bf16_f32 v40, v40, v40
v_and_b32 v40, 0xffff0000, v40
v_mul_f32 v40, s28, v40
v_cvt_pk_bf16_f32 v40, v40, v40
v_and_b32 v40, 0xffff0000, v40
v_cvt_pk_bf16_f32 v41, v41, v41
v_and_b32 v41, 0xffff0000, v41
v_mul_f32 v41, s28, v41
v_cvt_pk_bf16_f32 v41, v41, v41
v_and_b32 v41, 0xffff0000, v41
v_cvt_pk_bf16_f32 v42, v42, v42
v_and_b32 v42, 0xffff0000, v42
v_mul_f32 v42, s28, v42
v_cvt_pk_bf16_f32 v42, v42, v42
v_and_b32 v42, 0xffff0000, v42
v_cvt_pk_bf16_f32 v43, v43, v43
v_and_b32 v43, 0xffff0000, v43
v_mul_f32 v43, s28, v43
v_cvt_pk_bf16_f32 v43, v43, v43
v_and_b32 v43, 0xffff0000, v43
v_max3_f32 v44, v40, v41, v42
v_max3_f32 v44, v44, v43, v8
v_sub_f32 v45, v8, v44
v_mul_f32 v45, s29, v45
v_exp_f32 v45, v45
v_mov_b32 v8, v44
v_sub_f32 v40, v40, v44
v_mul_f32 v40, s29, v40
v_exp_f32 v40, v40
v_sub_f32 v41, v41, v44
v_mul_f32 v41, s29, v41
v_exp_f32 v41, v41
v_sub_f32 v42, v42, v44
v_mul_f32 v42, s29, v42
v_exp_f32 v42, v42
v_sub_f32 v43, v43, v44
v_mul_f32 v43, s29, v43
v_exp_f32 v43, v43
v_mul_f32 v9, v9, v45
v_mul_f32 v32, v32, v45
v_mul_f32 v33, v33, v45
v_mul_f32 v34, v34, v45
v_mul_f32 v35, v35, v45
v_mul_f32 v36, v36, v45
v_mul_f32 v37, v37, v45
v_mul_f32 v38, v38, v45
v_mul_f32 v39, v39, v45
v_add_f32 v9, v9, v40
v_add_f32 v9, v9, v41
v_add_f32 v9, v9, v42
v_add_f32 v9, v9, v43
s_waitcnt vmcnt(24)
v_lshlrev_b32 v46, 16, v144
v_and_b32 v47, 0xffff0000, v144
v_fmac_f32 v32, v40, v46
v_fmac_f32 v33, v40, v47
v_lshlrev_b32 v46, 16, v145
v_and_b32 v47, 0xffff0000, v145
v_fmac_f32 v34, v40, v46
v_fmac_f32 v35, v40, v47
v_lshlrev_b32 v46, 16, v146
v_and_b32 v47, 0xffff0000, v146
v_fmac_f32 v36, v40, v46
v_fmac_f32 v37, v40, v47
v_lshlrev_b32 v46, 16, v147
v_and_b32 v47, 0xffff0000, v147
v_fmac_f32 v38, v40, v46
v_fmac_f32 v39, v40, v47
v_lshlrev_b32 v46, 16, v148
v_and_b32 v47, 0xffff0000, v148
v_fmac_f32 v32, v41, v46
v_fmac_f32 v33, v41, v47
v_lshlrev_b32 v46, 16, v149
v_and_b32 v47, 0xffff0000, v149
v_fmac_f32 v34, v41, v46
v_fmac_f32 v35, v41, v47
v_lshlrev_b32 v46, 16, v150
v_and_b32 v47, 0xffff0000, v150
v_fmac_f32 v36, v41, v46
v_fmac_f32 v37, v41, v47
v_lshlrev_b32 v46, 16, v151
v_and_b32 v47, 0xffff0000, v151
v_fmac_f32 v38, v41, v46
v_fmac_f32 v39, v41, v47
v_lshlrev_b32 v46, 16, v152
v_and_b32 v47, 0xffff0000, v152
v_fmac_f32 v32, v42, v46
v_fmac_f32 v33, v42, v47
v_lshlrev_b32 v46, 16, v153
v_and_b32 v47, 0xffff0000, v153
v_fmac_f32 v34, v42, v46
v_fmac_f32 v35, v42, v47
v_lshlrev_b32 v46, 16, v154
v_and_b32 v47, 0xffff0000, v154
v_fmac_f32 v36, v42, v46
v_fmac_f32 v37, v42, v47
v_lshlrev_b32 v46, 16, v155
v_and_b32 v47, 0xffff0000, v155
v_fmac_f32 v38, v42, v46
v_fmac_f32 v39, v42, v47
v_lshlrev_b32 v46, 16, v156
v_and_b32 v47, 0xffff0000, v156
v_fmac_f32 v32, v43, v46
v_fmac_f32 v33, v43, v47
v_lshlrev_b32 v46, 16, v157
v_and_b32 v47, 0xffff0000, v157
v_fmac_f32 v34, v43, v46
v_fmac_f32 v35, v43, v47
v_lshlrev_b32 v46, 16, v158
v_and_b32 v47, 0xffff0000, v158
v_fmac_f32 v36, v43, v46
v_fmac_f32 v37, v43, v47
v_lshlrev_b32 v46, 16, v159
v_and_b32 v47, 0xffff0000, v159
v_fmac_f32 v38, v43, v46
v_fmac_f32 v39, v43, v47
s_add_u32 s27, s24, 327680
buffer_load_dwordx4 v[128:131], v5, s[12:15], s27 offen offset:0 nt
buffer_load_dwordx4 v[132:135], v5, s[12:15], s27 offen offset:64 nt
buffer_load_dwordx4 v[136:139], v5, s[12:15], s27 offen offset:128 nt
buffer_load_dwordx4 v[140:143], v5, s[12:15], s27 offen offset:192 nt
buffer_load_dwordx4 v[144:147], v6, s[16:19], s27 offen offset:0 nt
buffer_load_dwordx4 v[148:151], v6, s[16:19], s27 offen offset:256 nt
buffer_load_dwordx4 v[152:155], v6, s[16:19], s27 offen offset:512 nt
buffer_load_dwordx4 v[156:159], v6, s[16:19], s27 offen offset:768 nt
s_waitcnt vmcnt(28)
v_mfma_f32_16x16x32_bf16 v[40:43], v[160:163], v[16:19], 0
v_mfma_f32_16x16x32_bf16 v[40:43], v[164:167], v[20:23], v[40:43]
v_mfma_f32_16x16x32_bf16 v[40:43], v[168:171], v[24:27], v[40:43]
v_mfma_f32_16x16x32_bf16 v[40:43], v[172:175], v[28:31], v[40:43]
s_nop 7
s_nop 1
v_cvt_pk_bf16_f32 v40, v40, v40
v_and_b32 v40, 0xffff0000, v40
v_mul_f32 v40, s28, v40
v_cvt_pk_bf16_f32 v40, v40, v40
v_and_b32 v40, 0xffff0000, v40
v_cvt_pk_bf16_f32 v41, v41, v41
v_and_b32 v41, 0xffff0000, v41
v_mul_f32 v41, s28, v41
v_cvt_pk_bf16_f32 v41, v41, v41
v_and_b32 v41, 0xffff0000, v41
v_cvt_pk_bf16_f32 v42, v42, v42
v_and_b32 v42, 0xffff0000, v42
v_mul_f32 v42, s28, v42
v_cvt_pk_bf16_f32 v42, v42, v42
v_and_b32 v42, 0xffff0000, v42
v_cvt_pk_bf16_f32 v43, v43, v43
v_and_b32 v43, 0xffff0000, v43
v_mul_f32 v43, s28, v43
v_cvt_pk_bf16_f32 v43, v43, v43
v_and_b32 v43, 0xffff0000, v43
v_max3_f32 v44, v40, v41, v42
v_max3_f32 v44, v44, v43, v8
v_sub_f32 v45, v8, v44
v_mul_f32 v45, s29, v45
v_exp_f32 v45, v45
v_mov_b32 v8, v44
v_sub_f32 v40, v40, v44
v_mul_f32 v40, s29, v40
v_exp_f32 v40, v40
v_sub_f32 v41, v41, v44
v_mul_f32 v41, s29, v41
v_exp_f32 v41, v41
v_sub_f32 v42, v42, v44
v_mul_f32 v42, s29, v42
v_exp_f32 v42, v42
v_sub_f32 v43, v43, v44
v_mul_f32 v43, s29, v43
v_exp_f32 v43, v43
v_mul_f32 v9, v9, v45
v_mul_f32 v32, v32, v45
v_mul_f32 v33, v33, v45
v_mul_f32 v34, v34, v45
v_mul_f32 v35, v35, v45
v_mul_f32 v36, v36, v45
v_mul_f32 v37, v37, v45
v_mul_f32 v38, v38, v45
v_mul_f32 v39, v39, v45
v_add_f32 v9, v9, v40
v_add_f32 v9, v9, v41
v_add_f32 v9, v9, v42
v_add_f32 v9, v9, v43
s_waitcnt vmcnt(24)
v_lshlrev_b32 v46, 16, v176
v_and_b32 v47, 0xffff0000, v176
v_fmac_f32 v32, v40, v46
v_fmac_f32 v33, v40, v47
v_lshlrev_b32 v46, 16, v177
v_and_b32 v47, 0xffff0000, v177
v_fmac_f32 v34, v40, v46
v_fmac_f32 v35, v40, v47
v_lshlrev_b32 v46, 16, v178
v_and_b32 v47, 0xffff0000, v178
v_fmac_f32 v36, v40, v46
v_fmac_f32 v37, v40, v47
v_lshlrev_b32 v46, 16, v179
v_and_b32 v47, 0xffff0000, v179
v_fmac_f32 v38, v40, v46
v_fmac_f32 v39, v40, v47
v_lshlrev_b32 v46, 16, v180
v_and_b32 v47, 0xffff0000, v180
v_fmac_f32 v32, v41, v46
v_fmac_f32 v33, v41, v47
v_lshlrev_b32 v46, 16, v181
v_and_b32 v47, 0xffff0000, v181
v_fmac_f32 v34, v41, v46
v_fmac_f32 v35, v41, v47
v_lshlrev_b32 v46, 16, v182
v_and_b32 v47, 0xffff0000, v182
v_fmac_f32 v36, v41, v46
v_fmac_f32 v37, v41, v47
v_lshlrev_b32 v46, 16, v183
v_and_b32 v47, 0xffff0000, v183
v_fmac_f32 v38, v41, v46
v_fmac_f32 v39, v41, v47
v_lshlrev_b32 v46, 16, v184
v_and_b32 v47, 0xffff0000, v184
v_fmac_f32 v32, v42, v46
v_fmac_f32 v33, v42, v47
v_lshlrev_b32 v46, 16, v185
v_and_b32 v47, 0xffff0000, v185
v_fmac_f32 v34, v42, v46
v_fmac_f32 v35, v42, v47
v_lshlrev_b32 v46, 16, v186
v_and_b32 v47, 0xffff0000, v186
v_fmac_f32 v36, v42, v46
v_fmac_f32 v37, v42, v47
v_lshlrev_b32 v46, 16, v187
v_and_b32 v47, 0xffff0000, v187
v_fmac_f32 v38, v42, v46
v_fmac_f32 v39, v42, v47
v_lshlrev_b32 v46, 16, v188
v_and_b32 v47, 0xffff0000, v188
v_fmac_f32 v32, v43, v46
v_fmac_f32 v33, v43, v47
v_lshlrev_b32 v46, 16, v189
v_and_b32 v47, 0xffff0000, v189
v_fmac_f32 v34, v43, v46
v_fmac_f32 v35, v43, v47
v_lshlrev_b32 v46, 16, v190
v_and_b32 v47, 0xffff0000, v190
v_fmac_f32 v36, v43, v46
v_fmac_f32 v37, v43, v47
v_lshlrev_b32 v46, 16, v191
v_and_b32 v47, 0xffff0000, v191
v_fmac_f32 v38, v43, v46
v_fmac_f32 v39, v43, v47
s_add_u32 s27, s24, 360448
buffer_load_dwordx4 v[160:163], v5, s[12:15], s27 offen offset:0 nt
buffer_load_dwordx4 v[164:167], v5, s[12:15], s27 offen offset:64 nt
buffer_load_dwordx4 v[168:171], v5, s[12:15], s27 offen offset:128 nt
buffer_load_dwordx4 v[172:175], v5, s[12:15], s27 offen offset:192 nt
buffer_load_dwordx4 v[176:179], v6, s[16:19], s27 offen offset:0 nt
buffer_load_dwordx4 v[180:183], v6, s[16:19], s27 offen offset:256 nt
buffer_load_dwordx4 v[184:187], v6, s[16:19], s27 offen offset:512 nt
buffer_load_dwordx4 v[188:191], v6, s[16:19], s27 offen offset:768 nt
s_waitcnt vmcnt(28)
v_mfma_f32_16x16x32_bf16 v[40:43], v[64:67], v[16:19], 0
v_mfma_f32_16x16x32_bf16 v[40:43], v[68:71], v[20:23], v[40:43]
v_mfma_f32_16x16x32_bf16 v[40:43], v[72:75], v[24:27], v[40:43]
v_mfma_f32_16x16x32_bf16 v[40:43], v[76:79], v[28:31], v[40:43]
s_nop 7
s_nop 1
v_cvt_pk_bf16_f32 v40, v40, v40
v_and_b32 v40, 0xffff0000, v40
v_mul_f32 v40, s28, v40
v_cvt_pk_bf16_f32 v40, v40, v40
v_and_b32 v40, 0xffff0000, v40
v_cvt_pk_bf16_f32 v41, v41, v41
v_and_b32 v41, 0xffff0000, v41
v_mul_f32 v41, s28, v41
v_cvt_pk_bf16_f32 v41, v41, v41
v_and_b32 v41, 0xffff0000, v41
v_cvt_pk_bf16_f32 v42, v42, v42
v_and_b32 v42, 0xffff0000, v42
v_mul_f32 v42, s28, v42
v_cvt_pk_bf16_f32 v42, v42, v42
v_and_b32 v42, 0xffff0000, v42
v_cvt_pk_bf16_f32 v43, v43, v43
v_and_b32 v43, 0xffff0000, v43
v_mul_f32 v43, s28, v43
v_cvt_pk_bf16_f32 v43, v43, v43
v_and_b32 v43, 0xffff0000, v43
v_max3_f32 v44, v40, v41, v42
v_max3_f32 v44, v44, v43, v8
v_sub_f32 v45, v8, v44
v_mul_f32 v45, s29, v45
v_exp_f32 v45, v45
v_mov_b32 v8, v44
v_sub_f32 v40, v40, v44
v_mul_f32 v40, s29, v40
v_exp_f32 v40, v40
v_sub_f32 v41, v41, v44
v_mul_f32 v41, s29, v41
v_exp_f32 v41, v41
v_sub_f32 v42, v42, v44
v_mul_f32 v42, s29, v42
v_exp_f32 v42, v42
v_sub_f32 v43, v43, v44
v_mul_f32 v43, s29, v43
v_exp_f32 v43, v43
v_mul_f32 v9, v9, v45
v_mul_f32 v32, v32, v45
v_mul_f32 v33, v33, v45
v_mul_f32 v34, v34, v45
v_mul_f32 v35, v35, v45
v_mul_f32 v36, v36, v45
v_mul_f32 v37, v37, v45
v_mul_f32 v38, v38, v45
v_mul_f32 v39, v39, v45
v_add_f32 v9, v9, v40
v_add_f32 v9, v9, v41
v_add_f32 v9, v9, v42
v_add_f32 v9, v9, v43
s_waitcnt vmcnt(24)
v_lshlrev_b32 v46, 16, v80
v_and_b32 v47, 0xffff0000, v80
v_fmac_f32 v32, v40, v46
v_fmac_f32 v33, v40, v47
v_lshlrev_b32 v46, 16, v81
v_and_b32 v47, 0xffff0000, v81
v_fmac_f32 v34, v40, v46
v_fmac_f32 v35, v40, v47
v_lshlrev_b32 v46, 16, v82
v_and_b32 v47, 0xffff0000, v82
v_fmac_f32 v36, v40, v46
v_fmac_f32 v37, v40, v47
v_lshlrev_b32 v46, 16, v83
v_and_b32 v47, 0xffff0000, v83
v_fmac_f32 v38, v40, v46
v_fmac_f32 v39, v40, v47
v_lshlrev_b32 v46, 16, v84
v_and_b32 v47, 0xffff0000, v84
v_fmac_f32 v32, v41, v46
v_fmac_f32 v33, v41, v47
v_lshlrev_b32 v46, 16, v85
v_and_b32 v47, 0xffff0000, v85
v_fmac_f32 v34, v41, v46
v_fmac_f32 v35, v41, v47
v_lshlrev_b32 v46, 16, v86
v_and_b32 v47, 0xffff0000, v86
v_fmac_f32 v36, v41, v46
v_fmac_f32 v37, v41, v47
v_lshlrev_b32 v46, 16, v87
v_and_b32 v47, 0xffff0000, v87
v_fmac_f32 v38, v41, v46
v_fmac_f32 v39, v41, v47
v_lshlrev_b32 v46, 16, v88
v_and_b32 v47, 0xffff0000, v88
v_fmac_f32 v32, v42, v46
v_fmac_f32 v33, v42, v47
v_lshlrev_b32 v46, 16, v89
v_and_b32 v47, 0xffff0000, v89
v_fmac_f32 v34, v42, v46
v_fmac_f32 v35, v42, v47
v_lshlrev_b32 v46, 16, v90
v_and_b32 v47, 0xffff0000, v90
v_fmac_f32 v36, v42, v46
v_fmac_f32 v37, v42, v47
v_lshlrev_b32 v46, 16, v91
v_and_b32 v47, 0xffff0000, v91
v_fmac_f32 v38, v42, v46
v_fmac_f32 v39, v42, v47
v_lshlrev_b32 v46, 16, v92
v_and_b32 v47, 0xffff0000, v92
v_fmac_f32 v32, v43, v46
v_fmac_f32 v33, v43, v47
v_lshlrev_b32 v46, 16, v93
v_and_b32 v47, 0xffff0000, v93
v_fmac_f32 v34, v43, v46
v_fmac_f32 v35, v43, v47
v_lshlrev_b32 v46, 16, v94
v_and_b32 v47, 0xffff0000, v94
v_fmac_f32 v36, v43, v46
v_fmac_f32 v37, v43, v47
v_lshlrev_b32 v46, 16, v95
v_and_b32 v47, 0xffff0000, v95
v_fmac_f32 v38, v43, v46
v_fmac_f32 v39, v43, v47
s_add_u32 s27, s24, 393216
buffer_load_dwordx4 v[64:67], v5, s[12:15], s27 offen offset:0 nt
buffer_load_dwordx4 v[68:71], v5, s[12:15], s27 offen offset:64 nt
buffer_load_dwordx4 v[72:75], v5, s[12:15], s27 offen offset:128 nt
buffer_load_dwordx4 v[76:79], v5, s[12:15], s27 offen offset:192 nt
buffer_load_dwordx4 v[80:83], v6, s[16:19], s27 offen offset:0 nt
buffer_load_dwordx4 v[84:87], v6, s[16:19], s27 offen offset:256 nt
buffer_load_dwordx4 v[88:91], v6, s[16:19], s27 offen offset:512 nt
buffer_load_dwordx4 v[92:95], v6, s[16:19], s27 offen offset:768 nt
s_waitcnt vmcnt(28)
v_mfma_f32_16x16x32_bf16 v[40:43], v[96:99], v[16:19], 0
v_mfma_f32_16x16x32_bf16 v[40:43], v[100:103], v[20:23], v[40:43]
v_mfma_f32_16x16x32_bf16 v[40:43], v[104:107], v[24:27], v[40:43]
v_mfma_f32_16x16x32_bf16 v[40:43], v[108:111], v[28:31], v[40:43]
s_nop 7
s_nop 1
v_cvt_pk_bf16_f32 v40, v40, v40
v_and_b32 v40, 0xffff0000, v40
v_mul_f32 v40, s28, v40
v_cvt_pk_bf16_f32 v40, v40, v40
v_and_b32 v40, 0xffff0000, v40
v_cvt_pk_bf16_f32 v41, v41, v41
v_and_b32 v41, 0xffff0000, v41
v_mul_f32 v41, s28, v41
v_cvt_pk_bf16_f32 v41, v41, v41
v_and_b32 v41, 0xffff0000, v41
v_cvt_pk_bf16_f32 v42, v42, v42
v_and_b32 v42, 0xffff0000, v42
v_mul_f32 v42, s28, v42
v_cvt_pk_bf16_f32 v42, v42, v42
v_and_b32 v42, 0xffff0000, v42
v_cvt_pk_bf16_f32 v43, v43, v43
v_and_b32 v43, 0xffff0000, v43
v_mul_f32 v43, s28, v43
v_cvt_pk_bf16_f32 v43, v43, v43
v_and_b32 v43, 0xffff0000, v43
v_max3_f32 v44, v40, v41, v42
v_max3_f32 v44, v44, v43, v8
v_sub_f32 v45, v8, v44
v_mul_f32 v45, s29, v45
v_exp_f32 v45, v45
v_mov_b32 v8, v44
v_sub_f32 v40, v40, v44
v_mul_f32 v40, s29, v40
v_exp_f32 v40, v40
v_sub_f32 v41, v41, v44
v_mul_f32 v41, s29, v41
v_exp_f32 v41, v41
v_sub_f32 v42, v42, v44
v_mul_f32 v42, s29, v42
v_exp_f32 v42, v42
v_sub_f32 v43, v43, v44
v_mul_f32 v43, s29, v43
v_exp_f32 v43, v43
v_mul_f32 v9, v9, v45
v_mul_f32 v32, v32, v45
v_mul_f32 v33, v33, v45
v_mul_f32 v34, v34, v45
v_mul_f32 v35, v35, v45
v_mul_f32 v36, v36, v45
v_mul_f32 v37, v37, v45
v_mul_f32 v38, v38, v45
v_mul_f32 v39, v39, v45
v_add_f32 v9, v9, v40
v_add_f32 v9, v9, v41
v_add_f32 v9, v9, v42
v_add_f32 v9, v9, v43
s_waitcnt vmcnt(24)
v_lshlrev_b32 v46, 16, v112
v_and_b32 v47, 0xffff0000, v112
v_fmac_f32 v32, v40, v46
v_fmac_f32 v33, v40, v47
v_lshlrev_b32 v46, 16, v113
v_and_b32 v47, 0xffff0000, v113
v_fmac_f32 v34, v40, v46
v_fmac_f32 v35, v40, v47
v_lshlrev_b32 v46, 16, v114
v_and_b32 v47, 0xffff0000, v114
v_fmac_f32 v36, v40, v46
v_fmac_f32 v37, v40, v47
v_lshlrev_b32 v46, 16, v115
v_and_b32 v47, 0xffff0000, v115
v_fmac_f32 v38, v40, v46
v_fmac_f32 v39, v40, v47
v_lshlrev_b32 v46, 16, v116
v_and_b32 v47, 0xffff0000, v116
v_fmac_f32 v32, v41, v46
v_fmac_f32 v33, v41, v47
v_lshlrev_b32 v46, 16, v117
v_and_b32 v47, 0xffff0000, v117
v_fmac_f32 v34, v41, v46
v_fmac_f32 v35, v41, v47
v_lshlrev_b32 v46, 16, v118
v_and_b32 v47, 0xffff0000, v118
v_fmac_f32 v36, v41, v46
v_fmac_f32 v37, v41, v47
v_lshlrev_b32 v46, 16, v119
v_and_b32 v47, 0xffff0000, v119
v_fmac_f32 v38, v41, v46
v_fmac_f32 v39, v41, v47
v_lshlrev_b32 v46, 16, v120
v_and_b32 v47, 0xffff0000, v120
v_fmac_f32 v32, v42, v46
v_fmac_f32 v33, v42, v47
v_lshlrev_b32 v46, 16, v121
v_and_b32 v47, 0xffff0000, v121
v_fmac_f32 v34, v42, v46
v_fmac_f32 v35, v42, v47
v_lshlrev_b32 v46, 16, v122
v_and_b32 v47, 0xffff0000, v122
v_fmac_f32 v36, v42, v46
v_fmac_f32 v37, v42, v47
v_lshlrev_b32 v46, 16, v123
v_and_b32 v47, 0xffff0000, v123
v_fmac_f32 v38, v42, v46
v_fmac_f32 v39, v42, v47
v_lshlrev_b32 v46, 16, v124
v_and_b32 v47, 0xffff0000, v124
v_fmac_f32 v32, v43, v46
v_fmac_f32 v33, v43, v47
v_lshlrev_b32 v46, 16, v125
v_and_b32 v47, 0xffff0000, v125
v_fmac_f32 v34, v43, v46
v_fmac_f32 v35, v43, v47
v_lshlrev_b32 v46, 16, v126
v_and_b32 v47, 0xffff0000, v126
v_fmac_f32 v36, v43, v46
v_fmac_f32 v37, v43, v47
v_lshlrev_b32 v46, 16, v127
v_and_b32 v47, 0xffff0000, v127
v_fmac_f32 v38, v43, v46
v_fmac_f32 v39, v43, v47
s_add_u32 s27, s24, 425984
buffer_load_dwordx4 v[96:99], v5, s[12:15], s27 offen offset:0 nt
buffer_load_dwordx4 v[100:103], v5, s[12:15], s27 offen offset:64 nt
buffer_load_dwordx4 v[104:107], v5, s[12:15], s27 offen offset:128 nt
buffer_load_dwordx4 v[108:111], v5, s[12:15], s27 offen offset:192 nt
buffer_load_dwordx4 v[112:115], v6, s[16:19], s27 offen offset:0 nt
buffer_load_dwordx4 v[116:119], v6, s[16:19], s27 offen offset:256 nt
buffer_load_dwordx4 v[120:123], v6, s[16:19], s27 offen offset:512 nt
buffer_load_dwordx4 v[124:127], v6, s[16:19], s27 offen offset:768 nt
s_waitcnt vmcnt(28)
v_mfma_f32_16x16x32_bf16 v[40:43], v[128:131], v[16:19], 0
v_mfma_f32_16x16x32_bf16 v[40:43], v[132:135], v[20:23], v[40:43]
v_mfma_f32_16x16x32_bf16 v[40:43], v[136:139], v[24:27], v[40:43]
v_mfma_f32_16x16x32_bf16 v[40:43], v[140:143], v[28:31], v[40:43]
s_nop 7
s_nop 1
v_cvt_pk_bf16_f32 v40, v40, v40
v_and_b32 v40, 0xffff0000, v40
v_mul_f32 v40, s28, v40
v_cvt_pk_bf16_f32 v40, v40, v40
v_and_b32 v40, 0xffff0000, v40
v_cvt_pk_bf16_f32 v41, v41, v41
v_and_b32 v41, 0xffff0000, v41
v_mul_f32 v41, s28, v41
v_cvt_pk_bf16_f32 v41, v41, v41
v_and_b32 v41, 0xffff0000, v41
v_cvt_pk_bf16_f32 v42, v42, v42
v_and_b32 v42, 0xffff0000, v42
v_mul_f32 v42, s28, v42
v_cvt_pk_bf16_f32 v42, v42, v42
v_and_b32 v42, 0xffff0000, v42
v_cvt_pk_bf16_f32 v43, v43, v43
v_and_b32 v43, 0xffff0000, v43
v_mul_f32 v43, s28, v43
v_cvt_pk_bf16_f32 v43, v43, v43
v_and_b32 v43, 0xffff0000, v43
v_max3_f32 v44, v40, v41, v42
v_max3_f32 v44, v44, v43, v8
v_sub_f32 v45, v8, v44
v_mul_f32 v45, s29, v45
v_exp_f32 v45, v45
v_mov_b32 v8, v44
v_sub_f32 v40, v40, v44
v_mul_f32 v40, s29, v40
v_exp_f32 v40, v40
v_sub_f32 v41, v41, v44
v_mul_f32 v41, s29, v41
v_exp_f32 v41, v41
v_sub_f32 v42, v42, v44
v_mul_f32 v42, s29, v42
v_exp_f32 v42, v42
v_sub_f32 v43, v43, v44
v_mul_f32 v43, s29, v43
v_exp_f32 v43, v43
v_mul_f32 v9, v9, v45
v_mul_f32 v32, v32, v45
v_mul_f32 v33, v33, v45
v_mul_f32 v34, v34, v45
v_mul_f32 v35, v35, v45
v_mul_f32 v36, v36, v45
v_mul_f32 v37, v37, v45
v_mul_f32 v38, v38, v45
v_mul_f32 v39, v39, v45
v_add_f32 v9, v9, v40
v_add_f32 v9, v9, v41
v_add_f32 v9, v9, v42
v_add_f32 v9, v9, v43
s_waitcnt vmcnt(24)
v_lshlrev_b32 v46, 16, v144
v_and_b32 v47, 0xffff0000, v144
v_fmac_f32 v32, v40, v46
v_fmac_f32 v33, v40, v47
v_lshlrev_b32 v46, 16, v145
v_and_b32 v47, 0xffff0000, v145
v_fmac_f32 v34, v40, v46
v_fmac_f32 v35, v40, v47
v_lshlrev_b32 v46, 16, v146
v_and_b32 v47, 0xffff0000, v146
v_fmac_f32 v36, v40, v46
v_fmac_f32 v37, v40, v47
v_lshlrev_b32 v46, 16, v147
v_and_b32 v47, 0xffff0000, v147
v_fmac_f32 v38, v40, v46
v_fmac_f32 v39, v40, v47
v_lshlrev_b32 v46, 16, v148
v_and_b32 v47, 0xffff0000, v148
v_fmac_f32 v32, v41, v46
v_fmac_f32 v33, v41, v47
v_lshlrev_b32 v46, 16, v149
v_and_b32 v47, 0xffff0000, v149
v_fmac_f32 v34, v41, v46
v_fmac_f32 v35, v41, v47
v_lshlrev_b32 v46, 16, v150
v_and_b32 v47, 0xffff0000, v150
v_fmac_f32 v36, v41, v46
v_fmac_f32 v37, v41, v47
v_lshlrev_b32 v46, 16, v151
v_and_b32 v47, 0xffff0000, v151
v_fmac_f32 v38, v41, v46
v_fmac_f32 v39, v41, v47
v_lshlrev_b32 v46, 16, v152
v_and_b32 v47, 0xffff0000, v152
v_fmac_f32 v32, v42, v46
v_fmac_f32 v33, v42, v47
v_lshlrev_b32 v46, 16, v153
v_and_b32 v47, 0xffff0000, v153
v_fmac_f32 v34, v42, v46
v_fmac_f32 v35, v42, v47
v_lshlrev_b32 v46, 16, v154
v_and_b32 v47, 0xffff0000, v154
v_fmac_f32 v36, v42, v46
v_fmac_f32 v37, v42, v47
v_lshlrev_b32 v46, 16, v155
v_and_b32 v47, 0xffff0000, v155
v_fmac_f32 v38, v42, v46
v_fmac_f32 v39, v42, v47
v_lshlrev_b32 v46, 16, v156
v_and_b32 v47, 0xffff0000, v156
v_fmac_f32 v32, v43, v46
v_fmac_f32 v33, v43, v47
v_lshlrev_b32 v46, 16, v157
v_and_b32 v47, 0xffff0000, v157
v_fmac_f32 v34, v43, v46
v_fmac_f32 v35, v43, v47
v_lshlrev_b32 v46, 16, v158
v_and_b32 v47, 0xffff0000, v158
v_fmac_f32 v36, v43, v46
v_fmac_f32 v37, v43, v47
v_lshlrev_b32 v46, 16, v159
v_and_b32 v47, 0xffff0000, v159
v_fmac_f32 v38, v43, v46
v_fmac_f32 v39, v43, v47
s_add_u32 s27, s24, 458752
buffer_load_dwordx4 v[128:131], v5, s[12:15], s27 offen offset:0 nt
buffer_load_dwordx4 v[132:135], v5, s[12:15], s27 offen offset:64 nt
buffer_load_dwordx4 v[136:139], v5, s[12:15], s27 offen offset:128 nt
buffer_load_dwordx4 v[140:143], v5, s[12:15], s27 offen offset:192 nt
buffer_load_dwordx4 v[144:147], v6, s[16:19], s27 offen offset:0 nt
buffer_load_dwordx4 v[148:151], v6, s[16:19], s27 offen offset:256 nt
buffer_load_dwordx4 v[152:155], v6, s[16:19], s27 offen offset:512 nt
buffer_load_dwordx4 v[156:159], v6, s[16:19], s27 offen offset:768 nt
s_waitcnt vmcnt(28)
v_mfma_f32_16x16x32_bf16 v[40:43], v[160:163], v[16:19], 0
v_mfma_f32_16x16x32_bf16 v[40:43], v[164:167], v[20:23], v[40:43]
v_mfma_f32_16x16x32_bf16 v[40:43], v[168:171], v[24:27], v[40:43]
v_mfma_f32_16x16x32_bf16 v[40:43], v[172:175], v[28:31], v[40:43]
s_nop 7
s_nop 1
v_cvt_pk_bf16_f32 v40, v40, v40
v_and_b32 v40, 0xffff0000, v40
v_mul_f32 v40, s28, v40
v_cvt_pk_bf16_f32 v40, v40, v40
v_and_b32 v40, 0xffff0000, v40
v_cvt_pk_bf16_f32 v41, v41, v41
v_and_b32 v41, 0xffff0000, v41
v_mul_f32 v41, s28, v41
v_cvt_pk_bf16_f32 v41, v41, v41
v_and_b32 v41, 0xffff0000, v41
v_cvt_pk_bf16_f32 v42, v42, v42
v_and_b32 v42, 0xffff0000, v42
v_mul_f32 v42, s28, v42
v_cvt_pk_bf16_f32 v42, v42, v42
v_and_b32 v42, 0xffff0000, v42
v_cvt_pk_bf16_f32 v43, v43, v43
v_and_b32 v43, 0xffff0000, v43
v_mul_f32 v43, s28, v43
v_cvt_pk_bf16_f32 v43, v43, v43
v_and_b32 v43, 0xffff0000, v43
v_max3_f32 v44, v40, v41, v42
v_max3_f32 v44, v44, v43, v8
v_sub_f32 v45, v8, v44
v_mul_f32 v45, s29, v45
v_exp_f32 v45, v45
v_mov_b32 v8, v44
v_sub_f32 v40, v40, v44
v_mul_f32 v40, s29, v40
v_exp_f32 v40, v40
v_sub_f32 v41, v41, v44
v_mul_f32 v41, s29, v41
v_exp_f32 v41, v41
v_sub_f32 v42, v42, v44
v_mul_f32 v42, s29, v42
v_exp_f32 v42, v42
v_sub_f32 v43, v43, v44
v_mul_f32 v43, s29, v43
v_exp_f32 v43, v43
v_mul_f32 v9, v9, v45
v_mul_f32 v32, v32, v45
v_mul_f32 v33, v33, v45
v_mul_f32 v34, v34, v45
v_mul_f32 v35, v35, v45
v_mul_f32 v36, v36, v45
v_mul_f32 v37, v37, v45
v_mul_f32 v38, v38, v45
v_mul_f32 v39, v39, v45
v_add_f32 v9, v9, v40
v_add_f32 v9, v9, v41
v_add_f32 v9, v9, v42
v_add_f32 v9, v9, v43
s_waitcnt vmcnt(24)
v_lshlrev_b32 v46, 16, v176
v_and_b32 v47, 0xffff0000, v176
v_fmac_f32 v32, v40, v46
v_fmac_f32 v33, v40, v47
v_lshlrev_b32 v46, 16, v177
v_and_b32 v47, 0xffff0000, v177
v_fmac_f32 v34, v40, v46
v_fmac_f32 v35, v40, v47
v_lshlrev_b32 v46, 16, v178
v_and_b32 v47, 0xffff0000, v178
v_fmac_f32 v36, v40, v46
v_fmac_f32 v37, v40, v47
v_lshlrev_b32 v46, 16, v179
v_and_b32 v47, 0xffff0000, v179
v_fmac_f32 v38, v40, v46
v_fmac_f32 v39, v40, v47
v_lshlrev_b32 v46, 16, v180
v_and_b32 v47, 0xffff0000, v180
v_fmac_f32 v32, v41, v46
v_fmac_f32 v33, v41, v47
v_lshlrev_b32 v46, 16, v181
v_and_b32 v47, 0xffff0000, v181
v_fmac_f32 v34, v41, v46
v_fmac_f32 v35, v41, v47
v_lshlrev_b32 v46, 16, v182
v_and_b32 v47, 0xffff0000, v182
v_fmac_f32 v36, v41, v46
v_fmac_f32 v37, v41, v47
v_lshlrev_b32 v46, 16, v183
v_and_b32 v47, 0xffff0000, v183
v_fmac_f32 v38, v41, v46
v_fmac_f32 v39, v41, v47
v_lshlrev_b32 v46, 16, v184
v_and_b32 v47, 0xffff0000, v184
v_fmac_f32 v32, v42, v46
v_fmac_f32 v33, v42, v47
v_lshlrev_b32 v46, 16, v185
v_and_b32 v47, 0xffff0000, v185
v_fmac_f32 v34, v42, v46
v_fmac_f32 v35, v42, v47
v_lshlrev_b32 v46, 16, v186
v_and_b32 v47, 0xffff0000, v186
v_fmac_f32 v36, v42, v46
v_fmac_f32 v37, v42, v47
v_lshlrev_b32 v46, 16, v187
v_and_b32 v47, 0xffff0000, v187
v_fmac_f32 v38, v42, v46
v_fmac_f32 v39, v42, v47
v_lshlrev_b32 v46, 16, v188
v_and_b32 v47, 0xffff0000, v188
v_fmac_f32 v32, v43, v46
v_fmac_f32 v33, v43, v47
v_lshlrev_b32 v46, 16, v189
v_and_b32 v47, 0xffff0000, v189
v_fmac_f32 v34, v43, v46
v_fmac_f32 v35, v43, v47
v_lshlrev_b32 v46, 16, v190
v_and_b32 v47, 0xffff0000, v190
v_fmac_f32 v36, v43, v46
v_fmac_f32 v37, v43, v47
v_lshlrev_b32 v46, 16, v191
v_and_b32 v47, 0xffff0000, v191
v_fmac_f32 v38, v43, v46
v_fmac_f32 v39, v43, v47
s_add_u32 s27, s24, 491520
buffer_load_dwordx4 v[160:163], v5, s[12:15], s27 offen offset:0 nt
buffer_load_dwordx4 v[164:167], v5, s[12:15], s27 offen offset:64 nt
buffer_load_dwordx4 v[168:171], v5, s[12:15], s27 offen offset:128 nt
buffer_load_dwordx4 v[172:175], v5, s[12:15], s27 offen offset:192 nt
buffer_load_dwordx4 v[176:179], v6, s[16:19], s27 offen offset:0 nt
buffer_load_dwordx4 v[180:183], v6, s[16:19], s27 offen offset:256 nt
buffer_load_dwordx4 v[184:187], v6, s[16:19], s27 offen offset:512 nt
buffer_load_dwordx4 v[188:191], v6, s[16:19], s27 offen offset:768 nt
s_waitcnt vmcnt(28)
v_mfma_f32_16x16x32_bf16 v[40:43], v[64:67], v[16:19], 0
v_mfma_f32_16x16x32_bf16 v[40:43], v[68:71], v[20:23], v[40:43]
v_mfma_f32_16x16x32_bf16 v[40:43], v[72:75], v[24:27], v[40:43]
v_mfma_f32_16x16x32_bf16 v[40:43], v[76:79], v[28:31], v[40:43]
s_nop 7
s_nop 1
v_cvt_pk_bf16_f32 v40, v40, v40
v_and_b32 v40, 0xffff0000, v40
v_mul_f32 v40, s28, v40
v_cvt_pk_bf16_f32 v40, v40, v40
v_and_b32 v40, 0xffff0000, v40
v_cvt_pk_bf16_f32 v41, v41, v41
v_and_b32 v41, 0xffff0000, v41
v_mul_f32 v41, s28, v41
v_cvt_pk_bf16_f32 v41, v41, v41
v_and_b32 v41, 0xffff0000, v41
v_cvt_pk_bf16_f32 v42, v42, v42
v_and_b32 v42, 0xffff0000, v42
v_mul_f32 v42, s28, v42
v_cvt_pk_bf16_f32 v42, v42, v42
v_and_b32 v42, 0xffff0000, v42
v_cvt_pk_bf16_f32 v43, v43, v43
v_and_b32 v43, 0xffff0000, v43
v_mul_f32 v43, s28, v43
v_cvt_pk_bf16_f32 v43, v43, v43
v_and_b32 v43, 0xffff0000, v43
v_max3_f32 v44, v40, v41, v42
v_max3_f32 v44, v44, v43, v8
v_sub_f32 v45, v8, v44
v_mul_f32 v45, s29, v45
v_exp_f32 v45, v45
v_mov_b32 v8, v44
v_sub_f32 v40, v40, v44
v_mul_f32 v40, s29, v40
v_exp_f32 v40, v40
v_sub_f32 v41, v41, v44
v_mul_f32 v41, s29, v41
v_exp_f32 v41, v41
v_sub_f32 v42, v42, v44
v_mul_f32 v42, s29, v42
v_exp_f32 v42, v42
v_sub_f32 v43, v43, v44
v_mul_f32 v43, s29, v43
v_exp_f32 v43, v43
v_mul_f32 v9, v9, v45
v_mul_f32 v32, v32, v45
v_mul_f32 v33, v33, v45
v_mul_f32 v34, v34, v45
v_mul_f32 v35, v35, v45
v_mul_f32 v36, v36, v45
v_mul_f32 v37, v37, v45
v_mul_f32 v38, v38, v45
v_mul_f32 v39, v39, v45
v_add_f32 v9, v9, v40
v_add_f32 v9, v9, v41
v_add_f32 v9, v9, v42
v_add_f32 v9, v9, v43
s_waitcnt vmcnt(24)
v_lshlrev_b32 v46, 16, v80
v_and_b32 v47, 0xffff0000, v80
v_fmac_f32 v32, v40, v46
v_fmac_f32 v33, v40, v47
v_lshlrev_b32 v46, 16, v81
v_and_b32 v47, 0xffff0000, v81
v_fmac_f32 v34, v40, v46
v_fmac_f32 v35, v40, v47
v_lshlrev_b32 v46, 16, v82
v_and_b32 v47, 0xffff0000, v82
v_fmac_f32 v36, v40, v46
v_fmac_f32 v37, v40, v47
v_lshlrev_b32 v46, 16, v83
v_and_b32 v47, 0xffff0000, v83
v_fmac_f32 v38, v40, v46
v_fmac_f32 v39, v40, v47
v_lshlrev_b32 v46, 16, v84
v_and_b32 v47, 0xffff0000, v84
v_fmac_f32 v32, v41, v46
v_fmac_f32 v33, v41, v47
v_lshlrev_b32 v46, 16, v85
v_and_b32 v47, 0xffff0000, v85
v_fmac_f32 v34, v41, v46
v_fmac_f32 v35, v41, v47
v_lshlrev_b32 v46, 16, v86
v_and_b32 v47, 0xffff0000, v86
v_fmac_f32 v36, v41, v46
v_fmac_f32 v37, v41, v47
v_lshlrev_b32 v46, 16, v87
v_and_b32 v47, 0xffff0000, v87
v_fmac_f32 v38, v41, v46
v_fmac_f32 v39, v41, v47
v_lshlrev_b32 v46, 16, v88
v_and_b32 v47, 0xffff0000, v88
v_fmac_f32 v32, v42, v46
v_fmac_f32 v33, v42, v47
v_lshlrev_b32 v46, 16, v89
v_and_b32 v47, 0xffff0000, v89
v_fmac_f32 v34, v42, v46
v_fmac_f32 v35, v42, v47
v_lshlrev_b32 v46, 16, v90
v_and_b32 v47, 0xffff0000, v90
v_fmac_f32 v36, v42, v46
v_fmac_f32 v37, v42, v47
v_lshlrev_b32 v46, 16, v91
v_and_b32 v47, 0xffff0000, v91
v_fmac_f32 v38, v42, v46
v_fmac_f32 v39, v42, v47
v_lshlrev_b32 v46, 16, v92
v_and_b32 v47, 0xffff0000, v92
v_fmac_f32 v32, v43, v46
v_fmac_f32 v33, v43, v47
v_lshlrev_b32 v46, 16, v93
v_and_b32 v47, 0xffff0000, v93
v_fmac_f32 v34, v43, v46
v_fmac_f32 v35, v43, v47
v_lshlrev_b32 v46, 16, v94
v_and_b32 v47, 0xffff0000, v94
v_fmac_f32 v36, v43, v46
v_fmac_f32 v37, v43, v47
v_lshlrev_b32 v46, 16, v95
v_and_b32 v47, 0xffff0000, v95
v_fmac_f32 v38, v43, v46
v_fmac_f32 v39, v43, v47
s_waitcnt vmcnt(20)
v_mfma_f32_16x16x32_bf16 v[40:43], v[96:99], v[16:19], 0
v_mfma_f32_16x16x32_bf16 v[40:43], v[100:103], v[20:23], v[40:43]
v_mfma_f32_16x16x32_bf16 v[40:43], v[104:107], v[24:27], v[40:43]
v_mfma_f32_16x16x32_bf16 v[40:43], v[108:111], v[28:31], v[40:43]
s_nop 7
s_nop 1
v_cvt_pk_bf16_f32 v40, v40, v40
v_and_b32 v40, 0xffff0000, v40
v_mul_f32 v40, s28, v40
v_cvt_pk_bf16_f32 v40, v40, v40
v_and_b32 v40, 0xffff0000, v40
v_cvt_pk_bf16_f32 v41, v41, v41
v_and_b32 v41, 0xffff0000, v41
v_mul_f32 v41, s28, v41
v_cvt_pk_bf16_f32 v41, v41, v41
v_and_b32 v41, 0xffff0000, v41
v_cvt_pk_bf16_f32 v42, v42, v42
v_and_b32 v42, 0xffff0000, v42
v_mul_f32 v42, s28, v42
v_cvt_pk_bf16_f32 v42, v42, v42
v_and_b32 v42, 0xffff0000, v42
v_cvt_pk_bf16_f32 v43, v43, v43
v_and_b32 v43, 0xffff0000, v43
v_mul_f32 v43, s28, v43
v_cvt_pk_bf16_f32 v43, v43, v43
v_and_b32 v43, 0xffff0000, v43
v_max3_f32 v44, v40, v41, v42
v_max3_f32 v44, v44, v43, v8
v_sub_f32 v45, v8, v44
v_mul_f32 v45, s29, v45
v_exp_f32 v45, v45
v_mov_b32 v8, v44
v_sub_f32 v40, v40, v44
v_mul_f32 v40, s29, v40
v_exp_f32 v40, v40
v_sub_f32 v41, v41, v44
v_mul_f32 v41, s29, v41
v_exp_f32 v41, v41
v_sub_f32 v42, v42, v44
v_mul_f32 v42, s29, v42
v_exp_f32 v42, v42
v_sub_f32 v43, v43, v44
v_mul_f32 v43, s29, v43
v_exp_f32 v43, v43
v_mul_f32 v9, v9, v45
v_mul_f32 v32, v32, v45
v_mul_f32 v33, v33, v45
v_mul_f32 v34, v34, v45
v_mul_f32 v35, v35, v45
v_mul_f32 v36, v36, v45
v_mul_f32 v37, v37, v45
v_mul_f32 v38, v38, v45
v_mul_f32 v39, v39, v45
v_add_f32 v9, v9, v40
v_add_f32 v9, v9, v41
v_add_f32 v9, v9, v42
v_add_f32 v9, v9, v43
s_waitcnt vmcnt(16)
v_lshlrev_b32 v46, 16, v112
v_and_b32 v47, 0xffff0000, v112
v_fmac_f32 v32, v40, v46
v_fmac_f32 v33, v40, v47
v_lshlrev_b32 v46, 16, v113
v_and_b32 v47, 0xffff0000, v113
v_fmac_f32 v34, v40, v46
v_fmac_f32 v35, v40, v47
v_lshlrev_b32 v46, 16, v114
v_and_b32 v47, 0xffff0000, v114
v_fmac_f32 v36, v40, v46
v_fmac_f32 v37, v40, v47
v_lshlrev_b32 v46, 16, v115
v_and_b32 v47, 0xffff0000, v115
v_fmac_f32 v38, v40, v46
v_fmac_f32 v39, v40, v47
v_lshlrev_b32 v46, 16, v116
v_and_b32 v47, 0xffff0000, v116
v_fmac_f32 v32, v41, v46
v_fmac_f32 v33, v41, v47
v_lshlrev_b32 v46, 16, v117
v_and_b32 v47, 0xffff0000, v117
v_fmac_f32 v34, v41, v46
v_fmac_f32 v35, v41, v47
v_lshlrev_b32 v46, 16, v118
v_and_b32 v47, 0xffff0000, v118
v_fmac_f32 v36, v41, v46
v_fmac_f32 v37, v41, v47
v_lshlrev_b32 v46, 16, v119
v_and_b32 v47, 0xffff0000, v119
v_fmac_f32 v38, v41, v46
v_fmac_f32 v39, v41, v47
v_lshlrev_b32 v46, 16, v120
v_and_b32 v47, 0xffff0000, v120
v_fmac_f32 v32, v42, v46
v_fmac_f32 v33, v42, v47
v_lshlrev_b32 v46, 16, v121
v_and_b32 v47, 0xffff0000, v121
v_fmac_f32 v34, v42, v46
v_fmac_f32 v35, v42, v47
v_lshlrev_b32 v46, 16, v122
v_and_b32 v47, 0xffff0000, v122
v_fmac_f32 v36, v42, v46
v_fmac_f32 v37, v42, v47
v_lshlrev_b32 v46, 16, v123
v_and_b32 v47, 0xffff0000, v123
v_fmac_f32 v38, v42, v46
v_fmac_f32 v39, v42, v47
v_lshlrev_b32 v46, 16, v124
v_and_b32 v47, 0xffff0000, v124
v_fmac_f32 v32, v43, v46
v_fmac_f32 v33, v43, v47
v_lshlrev_b32 v46, 16, v125
v_and_b32 v47, 0xffff0000, v125
v_fmac_f32 v34, v43, v46
v_fmac_f32 v35, v43, v47
v_lshlrev_b32 v46, 16, v126
v_and_b32 v47, 0xffff0000, v126
v_fmac_f32 v36, v43, v46
v_fmac_f32 v37, v43, v47
v_lshlrev_b32 v46, 16, v127
v_and_b32 v47, 0xffff0000, v127
v_fmac_f32 v38, v43, v46
v_fmac_f32 v39, v43, v47
s_waitcnt vmcnt(12)
v_mfma_f32_16x16x32_bf16 v[40:43], v[128:131], v[16:19], 0
v_mfma_f32_16x16x32_bf16 v[40:43], v[132:135], v[20:23], v[40:43]
v_mfma_f32_16x16x32_bf16 v[40:43], v[136:139], v[24:27], v[40:43]
v_mfma_f32_16x16x32_bf16 v[40:43], v[140:143], v[28:31], v[40:43]
s_nop 7
s_nop 1
v_cvt_pk_bf16_f32 v40, v40, v40
v_and_b32 v40, 0xffff0000, v40
v_mul_f32 v40, s28, v40
v_cvt_pk_bf16_f32 v40, v40, v40
v_and_b32 v40, 0xffff0000, v40
v_cvt_pk_bf16_f32 v41, v41, v41
v_and_b32 v41, 0xffff0000, v41
v_mul_f32 v41, s28, v41
v_cvt_pk_bf16_f32 v41, v41, v41
v_and_b32 v41, 0xffff0000, v41
v_cvt_pk_bf16_f32 v42, v42, v42
v_and_b32 v42, 0xffff0000, v42
v_mul_f32 v42, s28, v42
v_cvt_pk_bf16_f32 v42, v42, v42
v_and_b32 v42, 0xffff0000, v42
v_cvt_pk_bf16_f32 v43, v43, v43
v_and_b32 v43, 0xffff0000, v43
v_mul_f32 v43, s28, v43
v_cvt_pk_bf16_f32 v43, v43, v43
v_and_b32 v43, 0xffff0000, v43
v_max3_f32 v44, v40, v41, v42
v_max3_f32 v44, v44, v43, v8
v_sub_f32 v45, v8, v44
v_mul_f32 v45, s29, v45
v_exp_f32 v45, v45
v_mov_b32 v8, v44
v_sub_f32 v40, v40, v44
v_mul_f32 v40, s29, v40
v_exp_f32 v40, v40
v_sub_f32 v41, v41, v44
v_mul_f32 v41, s29, v41
v_exp_f32 v41, v41
v_sub_f32 v42, v42, v44
v_mul_f32 v42, s29, v42
v_exp_f32 v42, v42
v_sub_f32 v43, v43, v44
v_mul_f32 v43, s29, v43
v_exp_f32 v43, v43
v_mul_f32 v9, v9, v45
v_mul_f32 v32, v32, v45
v_mul_f32 v33, v33, v45
v_mul_f32 v34, v34, v45
v_mul_f32 v35, v35, v45
v_mul_f32 v36, v36, v45
v_mul_f32 v37, v37, v45
v_mul_f32 v38, v38, v45
v_mul_f32 v39, v39, v45
v_add_f32 v9, v9, v40
v_add_f32 v9, v9, v41
v_add_f32 v9, v9, v42
v_add_f32 v9, v9, v43
s_waitcnt vmcnt(8)
v_lshlrev_b32 v46, 16, v144
v_and_b32 v47, 0xffff0000, v144
v_fmac_f32 v32, v40, v46
v_fmac_f32 v33, v40, v47
v_lshlrev_b32 v46, 16, v145
v_and_b32 v47, 0xffff0000, v145
v_fmac_f32 v34, v40, v46
v_fmac_f32 v35, v40, v47
v_lshlrev_b32 v46, 16, v146
v_and_b32 v47, 0xffff0000, v146
v_fmac_f32 v36, v40, v46
v_fmac_f32 v37, v40, v47
v_lshlrev_b32 v46, 16, v147
v_and_b32 v47, 0xffff0000, v147
v_fmac_f32 v38, v40, v46
v_fmac_f32 v39, v40, v47
v_lshlrev_b32 v46, 16, v148
v_and_b32 v47, 0xffff0000, v148
v_fmac_f32 v32, v41, v46
v_fmac_f32 v33, v41, v47
v_lshlrev_b32 v46, 16, v149
v_and_b32 v47, 0xffff0000, v149
v_fmac_f32 v34, v41, v46
v_fmac_f32 v35, v41, v47
v_lshlrev_b32 v46, 16, v150
v_and_b32 v47, 0xffff0000, v150
v_fmac_f32 v36, v41, v46
v_fmac_f32 v37, v41, v47
v_lshlrev_b32 v46, 16, v151
v_and_b32 v47, 0xffff0000, v151
v_fmac_f32 v38, v41, v46
v_fmac_f32 v39, v41, v47
v_lshlrev_b32 v46, 16, v152
v_and_b32 v47, 0xffff0000, v152
v_fmac_f32 v32, v42, v46
v_fmac_f32 v33, v42, v47
v_lshlrev_b32 v46, 16, v153
v_and_b32 v47, 0xffff0000, v153
v_fmac_f32 v34, v42, v46
v_fmac_f32 v35, v42, v47
v_lshlrev_b32 v46, 16, v154
v_and_b32 v47, 0xffff0000, v154
v_fmac_f32 v36, v42, v46
v_fmac_f32 v37, v42, v47
v_lshlrev_b32 v46, 16, v155
v_and_b32 v47, 0xffff0000, v155
v_fmac_f32 v38, v42, v46
v_fmac_f32 v39, v42, v47
v_lshlrev_b32 v46, 16, v156
v_and_b32 v47, 0xffff0000, v156
v_fmac_f32 v32, v43, v46
v_fmac_f32 v33, v43, v47
v_lshlrev_b32 v46, 16, v157
v_and_b32 v47, 0xffff0000, v157
v_fmac_f32 v34, v43, v46
v_fmac_f32 v35, v43, v47
v_lshlrev_b32 v46, 16, v158
v_and_b32 v47, 0xffff0000, v158
v_fmac_f32 v36, v43, v46
v_fmac_f32 v37, v43, v47
v_lshlrev_b32 v46, 16, v159
v_and_b32 v47, 0xffff0000, v159
v_fmac_f32 v38, v43, v46
v_fmac_f32 v39, v43, v47
s_waitcnt vmcnt(4)
v_mfma_f32_16x16x32_bf16 v[40:43], v[160:163], v[16:19], 0
v_mfma_f32_16x16x32_bf16 v[40:43], v[164:167], v[20:23], v[40:43]
v_mfma_f32_16x16x32_bf16 v[40:43], v[168:171], v[24:27], v[40:43]
v_mfma_f32_16x16x32_bf16 v[40:43], v[172:175], v[28:31], v[40:43]
s_nop 7
s_nop 1
v_cvt_pk_bf16_f32 v40, v40, v40
v_and_b32 v40, 0xffff0000, v40
v_mul_f32 v40, s28, v40
v_cvt_pk_bf16_f32 v40, v40, v40
v_and_b32 v40, 0xffff0000, v40
v_cvt_pk_bf16_f32 v41, v41, v41
v_and_b32 v41, 0xffff0000, v41
v_mul_f32 v41, s28, v41
v_cvt_pk_bf16_f32 v41, v41, v41
v_and_b32 v41, 0xffff0000, v41
v_cvt_pk_bf16_f32 v42, v42, v42
v_and_b32 v42, 0xffff0000, v42
v_mul_f32 v42, s28, v42
v_cvt_pk_bf16_f32 v42, v42, v42
v_and_b32 v42, 0xffff0000, v42
v_cvt_pk_bf16_f32 v43, v43, v43
v_and_b32 v43, 0xffff0000, v43
v_mul_f32 v43, s28, v43
v_cvt_pk_bf16_f32 v43, v43, v43
v_and_b32 v43, 0xffff0000, v43
v_max3_f32 v44, v40, v41, v42
v_max3_f32 v44, v44, v43, v8
v_sub_f32 v45, v8, v44
v_mul_f32 v45, s29, v45
v_exp_f32 v45, v45
v_mov_b32 v8, v44
v_sub_f32 v40, v40, v44
v_mul_f32 v40, s29, v40
v_exp_f32 v40, v40
v_sub_f32 v41, v41, v44
v_mul_f32 v41, s29, v41
v_exp_f32 v41, v41
v_sub_f32 v42, v42, v44
v_mul_f32 v42, s29, v42
v_exp_f32 v42, v42
v_sub_f32 v43, v43, v44
v_mul_f32 v43, s29, v43
v_exp_f32 v43, v43
v_mul_f32 v9, v9, v45
v_mul_f32 v32, v32, v45
v_mul_f32 v33, v33, v45
v_mul_f32 v34, v34, v45
v_mul_f32 v35, v35, v45
v_mul_f32 v36, v36, v45
v_mul_f32 v37, v37, v45
v_mul_f32 v38, v38, v45
v_mul_f32 v39, v39, v45
v_add_f32 v9, v9, v40
v_add_f32 v9, v9, v41
v_add_f32 v9, v9, v42
v_add_f32 v9, v9, v43
s_waitcnt vmcnt(0)
v_lshlrev_b32 v46, 16, v176
v_and_b32 v47, 0xffff0000, v176
v_fmac_f32 v32, v40, v46
v_fmac_f32 v33, v40, v47
v_lshlrev_b32 v46, 16, v177
v_and_b32 v47, 0xffff0000, v177
v_fmac_f32 v34, v40, v46
v_fmac_f32 v35, v40, v47
v_lshlrev_b32 v46, 16, v178
v_and_b32 v47, 0xffff0000, v178
v_fmac_f32 v36, v40, v46
v_fmac_f32 v37, v40, v47
v_lshlrev_b32 v46, 16, v179
v_and_b32 v47, 0xffff0000, v179
v_fmac_f32 v38, v40, v46
v_fmac_f32 v39, v40, v47
v_lshlrev_b32 v46, 16, v180
v_and_b32 v47, 0xffff0000, v180
v_fmac_f32 v32, v41, v46
v_fmac_f32 v33, v41, v47
v_lshlrev_b32 v46, 16, v181
v_and_b32 v47, 0xffff0000, v181
v_fmac_f32 v34, v41, v46
v_fmac_f32 v35, v41, v47
v_lshlrev_b32 v46, 16, v182
v_and_b32 v47, 0xffff0000, v182
v_fmac_f32 v36, v41, v46
v_fmac_f32 v37, v41, v47
v_lshlrev_b32 v46, 16, v183
v_and_b32 v47, 0xffff0000, v183
v_fmac_f32 v38, v41, v46
v_fmac_f32 v39, v41, v47
v_lshlrev_b32 v46, 16, v184
v_and_b32 v47, 0xffff0000, v184
v_fmac_f32 v32, v42, v46
v_fmac_f32 v33, v42, v47
v_lshlrev_b32 v46, 16, v185
v_and_b32 v47, 0xffff0000, v185
v_fmac_f32 v34, v42, v46
v_fmac_f32 v35, v42, v47
v_lshlrev_b32 v46, 16, v186
v_and_b32 v47, 0xffff0000, v186
v_fmac_f32 v36, v42, v46
v_fmac_f32 v37, v42, v47
v_lshlrev_b32 v46, 16, v187
v_and_b32 v47, 0xffff0000, v187
v_fmac_f32 v38, v42, v46
v_fmac_f32 v39, v42, v47
v_lshlrev_b32 v46, 16, v188
v_and_b32 v47, 0xffff0000, v188
v_fmac_f32 v32, v43, v46
v_fmac_f32 v33, v43, v47
v_lshlrev_b32 v46, 16, v189
v_and_b32 v47, 0xffff0000, v189
v_fmac_f32 v34, v43, v46
v_fmac_f32 v35, v43, v47
v_lshlrev_b32 v46, 16, v190
v_and_b32 v47, 0xffff0000, v190
v_fmac_f32 v36, v43, v46
v_fmac_f32 v37, v43, v47
v_lshlrev_b32 v46, 16, v191
v_and_b32 v47, 0xffff0000, v191
v_fmac_f32 v38, v43, v46
v_fmac_f32 v39, v43, v47
v_lshl_add_u32 v10, v2, 2, v4
v_lshlrev_b32 v11, 9, v10
v_lshl_add_u32 v11, v3, 5, v11
ds_write_b128 v11, v[32:35]
ds_write_b128 v11, v[36:39] offset:16
v_lshlrev_b32 v11, 2, v10
ds_write_b32 v11, v8 offset:16384
ds_write_b32 v11, v9 offset:16512
s_waitcnt lgkmcnt(0)
s_barrier
v_cmp_gt_u32 vcc, 128, v0
s_and_saveexec_b64 s[30:31], vcc
s_cbranch_execz k2_attn_kernel_done
v_mov_b32 v1, 0
ds_read_b128 v[64:67], v1 offset:16384
ds_read_b128 v[96:99], v1 offset:16512
ds_read_b128 v[68:71], v1 offset:16400
ds_read_b128 v[100:103], v1 offset:16528
ds_read_b128 v[72:75], v1 offset:16416
ds_read_b128 v[104:107], v1 offset:16544
ds_read_b128 v[76:79], v1 offset:16432
ds_read_b128 v[108:111], v1 offset:16560
ds_read_b128 v[80:83], v1 offset:16448
ds_read_b128 v[112:115], v1 offset:16576
ds_read_b128 v[84:87], v1 offset:16464
ds_read_b128 v[116:119], v1 offset:16592
ds_read_b128 v[88:91], v1 offset:16480
ds_read_b128 v[120:123], v1 offset:16608
ds_read_b128 v[92:95], v1 offset:16496
ds_read_b128 v[124:127], v1 offset:16624
v_lshlrev_b32 v2, 2, v0
ds_read_b32 v128, v2 offset:0
ds_read_b32 v129, v2 offset:512
ds_read_b32 v130, v2 offset:1024
ds_read_b32 v131, v2 offset:1536
ds_read_b32 v132, v2 offset:2048
ds_read_b32 v133, v2 offset:2560
ds_read_b32 v134, v2 offset:3072
ds_read_b32 v135, v2 offset:3584
ds_read_b32 v136, v2 offset:4096
ds_read_b32 v137, v2 offset:4608
ds_read_b32 v138, v2 offset:5120
ds_read_b32 v139, v2 offset:5632
ds_read_b32 v140, v2 offset:6144
ds_read_b32 v141, v2 offset:6656
ds_read_b32 v142, v2 offset:7168
ds_read_b32 v143, v2 offset:7680
ds_read_b32 v144, v2 offset:8192
ds_read_b32 v145, v2 offset:8704
ds_read_b32 v146, v2 offset:9216
ds_read_b32 v147, v2 offset:9728
ds_read_b32 v148, v2 offset:10240
ds_read_b32 v149, v2 offset:10752
ds_read_b32 v150, v2 offset:11264
ds_read_b32 v151, v2 offset:11776
ds_read_b32 v152, v2 offset:12288
ds_read_b32 v153, v2 offset:12800
ds_read_b32 v154, v2 offset:13312
ds_read_b32 v155, v2 offset:13824
ds_read_b32 v156, v2 offset:14336
ds_read_b32 v157, v2 offset:14848
ds_read_b32 v158, v2 offset:15360
ds_read_b32 v159, v2 offset:15872
s_waitcnt lgkmcnt(0)
v_max_f32 v3, v64, v65
v_max3_f32 v3, v3, v66, v67
v_max3_f32 v3, v3, v68, v69
v_max3_f32 v3, v3, v70, v71
v_max3_f32 v3, v3, v72, v73
v_max3_f32 v3, v3, v74, v75
v_max3_f32 v3, v3, v76, v77
v_max3_f32 v3, v3, v78, v79
v_max3_f32 v3, v3, v80, v81
v_max3_f32 v3, v3, v82, v83
v_max3_f32 v3, v3, v84, v85
v_max3_f32 v3, v3, v86, v87
v_max3_f32 v3, v3, v88, v89
v_max3_f32 v3, v3, v90, v91
v_max3_f32 v3, v3, v92, v93
v_max3_f32 v3, v3, v94, v95
v_mov_b32 v4, 0
v_mov_b32 v5, 0
v_sub_f32 v6, v64, v3
v_mul_f32 v6, s29, v6
v_exp_f32 v6, v6
s_nop 0
v_fmac_f32 v4, v6, v96
v_fmac_f32 v5, v6, v128
v_sub_f32 v6, v65, v3
v_mul_f32 v6, s29, v6
v_exp_f32 v6, v6
s_nop 0
v_fmac_f32 v4, v6, v97
v_fmac_f32 v5, v6, v129
v_sub_f32 v6, v66, v3
v_mul_f32 v6, s29, v6
v_exp_f32 v6, v6
s_nop 0
v_fmac_f32 v4, v6, v98
v_fmac_f32 v5, v6, v130
v_sub_f32 v6, v67, v3
v_mul_f32 v6, s29, v6
v_exp_f32 v6, v6
s_nop 0
v_fmac_f32 v4, v6, v99
v_fmac_f32 v5, v6, v131
v_sub_f32 v6, v68, v3
v_mul_f32 v6, s29, v6
v_exp_f32 v6, v6
s_nop 0
v_fmac_f32 v4, v6, v100
v_fmac_f32 v5, v6, v132
v_sub_f32 v6, v69, v3
v_mul_f32 v6, s29, v6
v_exp_f32 v6, v6
s_nop 0
v_fmac_f32 v4, v6, v101
v_fmac_f32 v5, v6, v133
v_sub_f32 v6, v70, v3
v_mul_f32 v6, s29, v6
v_exp_f32 v6, v6
s_nop 0
v_fmac_f32 v4, v6, v102
v_fmac_f32 v5, v6, v134
v_sub_f32 v6, v71, v3
v_mul_f32 v6, s29, v6
v_exp_f32 v6, v6
s_nop 0
v_fmac_f32 v4, v6, v103
v_fmac_f32 v5, v6, v135
v_sub_f32 v6, v72, v3
v_mul_f32 v6, s29, v6
v_exp_f32 v6, v6
s_nop 0
v_fmac_f32 v4, v6, v104
v_fmac_f32 v5, v6, v136
v_sub_f32 v6, v73, v3
v_mul_f32 v6, s29, v6
v_exp_f32 v6, v6
s_nop 0
v_fmac_f32 v4, v6, v105
v_fmac_f32 v5, v6, v137
v_sub_f32 v6, v74, v3
v_mul_f32 v6, s29, v6
v_exp_f32 v6, v6
s_nop 0
v_fmac_f32 v4, v6, v106
v_fmac_f32 v5, v6, v138
v_sub_f32 v6, v75, v3
v_mul_f32 v6, s29, v6
v_exp_f32 v6, v6
s_nop 0
v_fmac_f32 v4, v6, v107
v_fmac_f32 v5, v6, v139
v_sub_f32 v6, v76, v3
v_mul_f32 v6, s29, v6
v_exp_f32 v6, v6
s_nop 0
v_fmac_f32 v4, v6, v108
v_fmac_f32 v5, v6, v140
v_sub_f32 v6, v77, v3
v_mul_f32 v6, s29, v6
v_exp_f32 v6, v6
s_nop 0
v_fmac_f32 v4, v6, v109
v_fmac_f32 v5, v6, v141
v_sub_f32 v6, v78, v3
v_mul_f32 v6, s29, v6
v_exp_f32 v6, v6
s_nop 0
v_fmac_f32 v4, v6, v110
v_fmac_f32 v5, v6, v142
v_sub_f32 v6, v79, v3
v_mul_f32 v6, s29, v6
v_exp_f32 v6, v6
s_nop 0
v_fmac_f32 v4, v6, v111
v_fmac_f32 v5, v6, v143
v_sub_f32 v6, v80, v3
v_mul_f32 v6, s29, v6
v_exp_f32 v6, v6
s_nop 0
v_fmac_f32 v4, v6, v112
v_fmac_f32 v5, v6, v144
v_sub_f32 v6, v81, v3
v_mul_f32 v6, s29, v6
v_exp_f32 v6, v6
s_nop 0
v_fmac_f32 v4, v6, v113
v_fmac_f32 v5, v6, v145
v_sub_f32 v6, v82, v3
v_mul_f32 v6, s29, v6
v_exp_f32 v6, v6
s_nop 0
v_fmac_f32 v4, v6, v114
v_fmac_f32 v5, v6, v146
v_sub_f32 v6, v83, v3
v_mul_f32 v6, s29, v6
v_exp_f32 v6, v6
s_nop 0
v_fmac_f32 v4, v6, v115
v_fmac_f32 v5, v6, v147
v_sub_f32 v6, v84, v3
v_mul_f32 v6, s29, v6
v_exp_f32 v6, v6
s_nop 0
v_fmac_f32 v4, v6, v116
v_fmac_f32 v5, v6, v148
v_sub_f32 v6, v85, v3
v_mul_f32 v6, s29, v6
v_exp_f32 v6, v6
s_nop 0
v_fmac_f32 v4, v6, v117
v_fmac_f32 v5, v6, v149
v_sub_f32 v6, v86, v3
v_mul_f32 v6, s29, v6
v_exp_f32 v6, v6
s_nop 0
v_fmac_f32 v4, v6, v118
v_fmac_f32 v5, v6, v150
v_sub_f32 v6, v87, v3
v_mul_f32 v6, s29, v6
v_exp_f32 v6, v6
s_nop 0
v_fmac_f32 v4, v6, v119
v_fmac_f32 v5, v6, v151
v_sub_f32 v6, v88, v3
v_mul_f32 v6, s29, v6
v_exp_f32 v6, v6
s_nop 0
v_fmac_f32 v4, v6, v120
v_fmac_f32 v5, v6, v152
v_sub_f32 v6, v89, v3
v_mul_f32 v6, s29, v6
v_exp_f32 v6, v6
s_nop 0
v_fmac_f32 v4, v6, v121
v_fmac_f32 v5, v6, v153
v_sub_f32 v6, v90, v3
v_mul_f32 v6, s29, v6
v_exp_f32 v6, v6
s_nop 0
v_fmac_f32 v4, v6, v122
v_fmac_f32 v5, v6, v154
v_sub_f32 v6, v91, v3
v_mul_f32 v6, s29, v6
v_exp_f32 v6, v6
s_nop 0
v_fmac_f32 v4, v6, v123
v_fmac_f32 v5, v6, v155
v_sub_f32 v6, v92, v3
v_mul_f32 v6, s29, v6
v_exp_f32 v6, v6
s_nop 0
v_fmac_f32 v4, v6, v124
v_fmac_f32 v5, v6, v156
v_sub_f32 v6, v93, v3
v_mul_f32 v6, s29, v6
v_exp_f32 v6, v6
s_nop 0
v_fmac_f32 v4, v6, v125
v_fmac_f32 v5, v6, v157
v_sub_f32 v6, v94, v3
v_mul_f32 v6, s29, v6
v_exp_f32 v6, v6
s_nop 0
v_fmac_f32 v4, v6, v126
v_fmac_f32 v5, v6, v158
v_sub_f32 v6, v95, v3
v_mul_f32 v6, s29, v6
v_exp_f32 v6, v6
s_nop 0
v_fmac_f32 v4, v6, v127
v_fmac_f32 v5, v6, v159
s_lshl_b32 s26, s2, 10
s_add_u32 s26, s26, 131072
buffer_store_dword v5, v2, s[20:23], s26 offen
v_cmp_eq_u32 vcc, 0, v0
s_and_saveexec_b64 s[32:33], vcc
buffer_store_dword v3, v1, s[20:23], s26 offen offset:512
buffer_store_dword v4, v1, s[20:23], s26 offen offset:516
k2_attn_kernel_done:
s_endpgm
.globl k3_wo_kernel
.p2align 8
.type k3_wo_kernel,@function
k3_wo_kernel:
s_cmp_ge_u32 s2, 288
s_cbranch_scc1 k3_wo_kernel_done
s_load_dwordx2 s[6:7], s[0:1], 32
s_load_dwordx2 s[8:9], s[0:1], 104
s_waitcnt lgkmcnt(0)
s_mov_b32 s16, s6
s_and_b32 s17, s7, 0xffff
s_mov_b32 s18, 4718592
s_mov_b32 s19, 0x00020000
s_mov_b32 s20, s8
s_and_b32 s21, s9, 0xffff
s_mov_b32 s22, 536870912
s_mov_b32 s23, 0x00020000
s_lshr_b32 s24, s2, 5
s_and_b32 s25, s2, 31
s_mul_i32 s27, s25, 147456
s_lshl_b32 s24, s24, 7
s_add_u32 s27, s27, s24
v_and_b32 v1, 63, v0
v_lshrrev_b32 v2, 6, v0
v_lshrrev_b32 v3, 3, v1
v_and_b32 v1, 7, v1
v_mad_u32_u24 v3, v2, 8, v3
s_mov_b32 s90, 1152
v_mul_lo_u32 v4, v3, s90
v_lshl_add_u32 v4, v1, 4, v4
s_mov_b32 s91, s27
buffer_load_dwordx4 v[160:163], v4, s[16:19], s91 offen
s_add_u32 s91, s91, 36864
buffer_load_dwordx4 v[164:167], v4, s[16:19], s91 offen
s_add_u32 s91, s91, 36864
buffer_load_dwordx4 v[168:171], v4, s[16:19], s91 offen
s_add_u32 s91, s91, 36864
buffer_load_dwordx4 v[172:175], v4, s[16:19], s91 offen
v_and_b32 v1, 127, v0
v_lshrrev_b32 v2, 7, v0
v_lshlrev_b32 v3, 17, v2
v_lshl_add_u32 v4, v1, 2, v3
s_lshl_b32 s26, s25, 11
s_add_u32 s26, s26, 131072
buffer_load_dword v64, v4, s[20:23], s26 offen offset:0
buffer_load_dwordx2 v[72:73], v3, s[20:23], s26 offen offset:512
buffer_load_dword v65, v4, s[20:23], s26 offen offset:1024
buffer_load_dwordx2 v[74:75], v3, s[20:23], s26 offen offset:1536
v_add_u32 v5, 0x10000, v4
v_add_u32 v6, 0x10000, v3
buffer_load_dword v66, v5, s[20:23], s26 offen offset:0
buffer_load_dwordx2 v[76:77], v6, s[20:23], s26 offen offset:512
buffer_load_dword v67, v5, s[20:23], s26 offen offset:1024
buffer_load_dwordx2 v[78:79], v6, s[20:23], s26 offen offset:1536
s_waitcnt vmcnt(0)
s_mov_b32 s29, 0x3fb8aa3b
v_lshlrev_b32 v7, 4, v1
v_lshl_add_u32 v7, v2, 3, v7
v_max_f32 v8, v72, v74
v_sub_f32 v9, v72, v8
v_mul_f32 v9, s29, v9
v_exp_f32 v9, v9
v_sub_f32 v11, v74, v8
v_mul_f32 v11, s29, v11
v_exp_f32 v11, v11
s_nop 0
v_mul_f32 v12, v9, v73
v_fmac_f32 v12, v11, v75
v_rcp_f32 v12, v12
v_mul_f32 v13, v9, v64
v_fmac_f32 v13, v11, v65
v_mul_f32 v13, v13, v12
v_cvt_pk_bf16_f32 v13, v13, v13
v_and_b32 v13, 0xffff0000, v13
ds_write_b32 v7, v13 offset:0
v_max_f32 v8, v76, v78
v_sub_f32 v9, v76, v8
v_mul_f32 v9, s29, v9
v_exp_f32 v9, v9
v_sub_f32 v11, v78, v8
v_mul_f32 v11, s29, v11
v_exp_f32 v11, v11
s_nop 0
v_mul_f32 v12, v9, v77
v_fmac_f32 v12, v11, v79
v_rcp_f32 v12, v12
v_mul_f32 v13, v9, v66
v_fmac_f32 v13, v11, v67
v_mul_f32 v13, v13, v12
v_cvt_pk_bf16_f32 v13, v13, v13
v_and_b32 v13, 0xffff0000, v13
ds_write_b32 v7, v13 offset:4
s_waitcnt lgkmcnt(0)
s_barrier
v_and_b32 v1, 63, v0
v_lshrrev_b32 v2, 6, v0
v_lshrrev_b32 v3, 3, v1
v_and_b32 v1, 7, v1
v_mad_u32_u24 v3, v2, 8, v3
s_mov_b32 s90, 1152
v_mul_lo_u32 v4, v3, s90
v_lshl_add_u32 v4, v1, 4, v4
s_mov_b32 s91, s27
v_lshlrev_b32 v5, 4, v3
ds_read_b128 v[64:67], v5 offset:0
ds_read_b128 v[68:71], v5 offset:512
ds_read_b128 v[72:75], v5 offset:1024
ds_read_b128 v[76:79], v5 offset:1536
v_mov_b32 v32, 0
v_mov_b32 v33, 0
v_mov_b32 v34, 0
v_mov_b32 v35, 0
v_mov_b32 v36, 0
v_mov_b32 v37, 0
v_mov_b32 v38, 0
v_mov_b32 v39, 0
v_mov_b32 v40, 0
v_mov_b32 v41, 0
v_mov_b32 v42, 0
v_mov_b32 v43, 0
v_mov_b32 v44, 0
v_mov_b32 v45, 0
v_mov_b32 v46, 0
v_mov_b32 v47, 0
v_mov_b32 v48, 0
v_mov_b32 v49, 0
v_mov_b32 v50, 0
v_mov_b32 v51, 0
v_mov_b32 v52, 0
v_mov_b32 v53, 0
v_mov_b32 v54, 0
v_mov_b32 v55, 0
v_mov_b32 v56, 0
v_mov_b32 v57, 0
v_mov_b32 v58, 0
v_mov_b32 v59, 0
v_mov_b32 v60, 0
v_mov_b32 v61, 0
v_mov_b32 v62, 0
v_mov_b32 v63, 0
s_waitcnt lgkmcnt(0)
s_waitcnt vmcnt(3)
v_lshlrev_b32 v6, 16, v160
v_and_b32 v7, 0xffff0000, v160
v_fmac_f32 v32, v64, v6
v_fmac_f32 v33, v64, v7
v_fmac_f32 v40, v65, v6
v_fmac_f32 v41, v65, v7
v_fmac_f32 v48, v66, v6
v_fmac_f32 v49, v66, v7
v_fmac_f32 v56, v67, v6
v_fmac_f32 v57, v67, v7
v_lshlrev_b32 v6, 16, v161
v_and_b32 v7, 0xffff0000, v161
v_fmac_f32 v34, v64, v6
v_fmac_f32 v35, v64, v7
v_fmac_f32 v42, v65, v6
v_fmac_f32 v43, v65, v7
v_fmac_f32 v50, v66, v6
v_fmac_f32 v51, v66, v7
v_fmac_f32 v58, v67, v6
v_fmac_f32 v59, v67, v7
v_lshlrev_b32 v6, 16, v162
v_and_b32 v7, 0xffff0000, v162
v_fmac_f32 v36, v64, v6
v_fmac_f32 v37, v64, v7
v_fmac_f32 v44, v65, v6
v_fmac_f32 v45, v65, v7
v_fmac_f32 v52, v66, v6
v_fmac_f32 v53, v66, v7
v_fmac_f32 v60, v67, v6
v_fmac_f32 v61, v67, v7
v_lshlrev_b32 v6, 16, v163
v_and_b32 v7, 0xffff0000, v163
v_fmac_f32 v38, v64, v6
v_fmac_f32 v39, v64, v7
v_fmac_f32 v46, v65, v6
v_fmac_f32 v47, v65, v7
v_fmac_f32 v54, v66, v6
v_fmac_f32 v55, v66, v7
v_fmac_f32 v62, v67, v6
v_fmac_f32 v63, v67, v7
s_waitcnt vmcnt(2)
v_lshlrev_b32 v6, 16, v164
v_and_b32 v7, 0xffff0000, v164
v_fmac_f32 v32, v68, v6
v_fmac_f32 v33, v68, v7
v_fmac_f32 v40, v69, v6
v_fmac_f32 v41, v69, v7
v_fmac_f32 v48, v70, v6
v_fmac_f32 v49, v70, v7
v_fmac_f32 v56, v71, v6
v_fmac_f32 v57, v71, v7
v_lshlrev_b32 v6, 16, v165
v_and_b32 v7, 0xffff0000, v165
v_fmac_f32 v34, v68, v6
v_fmac_f32 v35, v68, v7
v_fmac_f32 v42, v69, v6
v_fmac_f32 v43, v69, v7
v_fmac_f32 v50, v70, v6
v_fmac_f32 v51, v70, v7
v_fmac_f32 v58, v71, v6
v_fmac_f32 v59, v71, v7
v_lshlrev_b32 v6, 16, v166
v_and_b32 v7, 0xffff0000, v166
v_fmac_f32 v36, v68, v6
v_fmac_f32 v37, v68, v7
v_fmac_f32 v44, v69, v6
v_fmac_f32 v45, v69, v7
v_fmac_f32 v52, v70, v6
v_fmac_f32 v53, v70, v7
v_fmac_f32 v60, v71, v6
v_fmac_f32 v61, v71, v7
v_lshlrev_b32 v6, 16, v167
v_and_b32 v7, 0xffff0000, v167
v_fmac_f32 v38, v68, v6
v_fmac_f32 v39, v68, v7
v_fmac_f32 v46, v69, v6
v_fmac_f32 v47, v69, v7
v_fmac_f32 v54, v70, v6
v_fmac_f32 v55, v70, v7
v_fmac_f32 v62, v71, v6
v_fmac_f32 v63, v71, v7
s_waitcnt vmcnt(1)
v_lshlrev_b32 v6, 16, v168
v_and_b32 v7, 0xffff0000, v168
v_fmac_f32 v32, v72, v6
v_fmac_f32 v33, v72, v7
v_fmac_f32 v40, v73, v6
v_fmac_f32 v41, v73, v7
v_fmac_f32 v48, v74, v6
v_fmac_f32 v49, v74, v7
v_fmac_f32 v56, v75, v6
v_fmac_f32 v57, v75, v7
v_lshlrev_b32 v6, 16, v169
v_and_b32 v7, 0xffff0000, v169
v_fmac_f32 v34, v72, v6
v_fmac_f32 v35, v72, v7
v_fmac_f32 v42, v73, v6
v_fmac_f32 v43, v73, v7
v_fmac_f32 v50, v74, v6
v_fmac_f32 v51, v74, v7
v_fmac_f32 v58, v75, v6
v_fmac_f32 v59, v75, v7
v_lshlrev_b32 v6, 16, v170
v_and_b32 v7, 0xffff0000, v170
v_fmac_f32 v36, v72, v6
v_fmac_f32 v37, v72, v7
v_fmac_f32 v44, v73, v6
v_fmac_f32 v45, v73, v7
v_fmac_f32 v52, v74, v6
v_fmac_f32 v53, v74, v7
v_fmac_f32 v60, v75, v6
v_fmac_f32 v61, v75, v7
v_lshlrev_b32 v6, 16, v171
v_and_b32 v7, 0xffff0000, v171
v_fmac_f32 v38, v72, v6
v_fmac_f32 v39, v72, v7
v_fmac_f32 v46, v73, v6
v_fmac_f32 v47, v73, v7
v_fmac_f32 v54, v74, v6
v_fmac_f32 v55, v74, v7
v_fmac_f32 v62, v75, v6
v_fmac_f32 v63, v75, v7
s_waitcnt vmcnt(0)
v_lshlrev_b32 v6, 16, v172
v_and_b32 v7, 0xffff0000, v172
v_fmac_f32 v32, v76, v6
v_fmac_f32 v33, v76, v7
v_fmac_f32 v40, v77, v6
v_fmac_f32 v41, v77, v7
v_fmac_f32 v48, v78, v6
v_fmac_f32 v49, v78, v7
v_fmac_f32 v56, v79, v6
v_fmac_f32 v57, v79, v7
v_lshlrev_b32 v6, 16, v173
v_and_b32 v7, 0xffff0000, v173
v_fmac_f32 v34, v76, v6
v_fmac_f32 v35, v76, v7
v_fmac_f32 v42, v77, v6
v_fmac_f32 v43, v77, v7
v_fmac_f32 v50, v78, v6
v_fmac_f32 v51, v78, v7
v_fmac_f32 v58, v79, v6
v_fmac_f32 v59, v79, v7
v_lshlrev_b32 v6, 16, v174
v_and_b32 v7, 0xffff0000, v174
v_fmac_f32 v36, v76, v6
v_fmac_f32 v37, v76, v7
v_fmac_f32 v44, v77, v6
v_fmac_f32 v45, v77, v7
v_fmac_f32 v52, v78, v6
v_fmac_f32 v53, v78, v7
v_fmac_f32 v60, v79, v6
v_fmac_f32 v61, v79, v7
v_lshlrev_b32 v6, 16, v175
v_and_b32 v7, 0xffff0000, v175
v_fmac_f32 v38, v76, v6
v_fmac_f32 v39, v76, v7
v_fmac_f32 v46, v77, v6
v_fmac_f32 v47, v77, v7
v_fmac_f32 v54, v78, v6
v_fmac_f32 v55, v78, v7
v_fmac_f32 v62, v79, v6
v_fmac_f32 v63, v79, v7
v_mul_u32_u24 v5, 1024, v3
v_lshl_add_u32 v5, v1, 5, v5
ds_write_b128 v5, v[32:35] offset:16384
ds_write_b128 v5, v[36:39] offset:16400
ds_write_b128 v5, v[40:43] offset:16640
ds_write_b128 v5, v[44:47] offset:16656
ds_write_b128 v5, v[48:51] offset:16896
ds_write_b128 v5, v[52:55] offset:16912
ds_write_b128 v5, v[56:59] offset:17152
ds_write_b128 v5, v[60:63] offset:17168
s_waitcnt lgkmcnt(0)
s_barrier
v_lshlrev_b32 v5, 2, v0
v_mov_b32 v10, 0
ds_read_b32 v64, v5 offset:16384
ds_read_b32 v65, v5 offset:17408
ds_read_b32 v66, v5 offset:18432
ds_read_b32 v67, v5 offset:19456
ds_read_b32 v68, v5 offset:20480
ds_read_b32 v69, v5 offset:21504
ds_read_b32 v70, v5 offset:22528
ds_read_b32 v71, v5 offset:23552
ds_read_b32 v72, v5 offset:24576
ds_read_b32 v73, v5 offset:25600
ds_read_b32 v74, v5 offset:26624
ds_read_b32 v75, v5 offset:27648
ds_read_b32 v76, v5 offset:28672
ds_read_b32 v77, v5 offset:29696
ds_read_b32 v78, v5 offset:30720
ds_read_b32 v79, v5 offset:31744
s_waitcnt lgkmcnt(0)
v_add_f32 v10, v10, v64
v_add_f32 v10, v10, v65
v_add_f32 v10, v10, v66
v_add_f32 v10, v10, v67
v_add_f32 v10, v10, v68
v_add_f32 v10, v10, v69
v_add_f32 v10, v10, v70
v_add_f32 v10, v10, v71
v_add_f32 v10, v10, v72
v_add_f32 v10, v10, v73
v_add_f32 v10, v10, v74
v_add_f32 v10, v10, v75
v_add_f32 v10, v10, v76
v_add_f32 v10, v10, v77
v_add_f32 v10, v10, v78
v_add_f32 v10, v10, v79
ds_read_b32 v64, v5 offset:32768
ds_read_b32 v65, v5 offset:33792
ds_read_b32 v66, v5 offset:34816
ds_read_b32 v67, v5 offset:35840
ds_read_b32 v68, v5 offset:36864
ds_read_b32 v69, v5 offset:37888
ds_read_b32 v70, v5 offset:38912
ds_read_b32 v71, v5 offset:39936
ds_read_b32 v72, v5 offset:40960
ds_read_b32 v73, v5 offset:41984
ds_read_b32 v74, v5 offset:43008
ds_read_b32 v75, v5 offset:44032
ds_read_b32 v76, v5 offset:45056
ds_read_b32 v77, v5 offset:46080
ds_read_b32 v78, v5 offset:47104
ds_read_b32 v79, v5 offset:48128
s_waitcnt lgkmcnt(0)
v_add_f32 v10, v10, v64
v_add_f32 v10, v10, v65
v_add_f32 v10, v10, v66
v_add_f32 v10, v10, v67
v_add_f32 v10, v10, v68
v_add_f32 v10, v10, v69
v_add_f32 v10, v10, v70
v_add_f32 v10, v10, v71
v_add_f32 v10, v10, v72
v_add_f32 v10, v10, v73
v_add_f32 v10, v10, v74
v_add_f32 v10, v10, v75
v_add_f32 v10, v10, v76
v_add_f32 v10, v10, v77
v_add_f32 v10, v10, v78
v_add_f32 v10, v10, v79
v_lshrrev_b32 v2, 6, v0
v_and_b32 v1, 63, v0
v_mul_u32_u24 v2, 2304, v2
v_lshl_add_u32 v2, v1, 2, v2
s_lshl_b32 s24, s24, 1
s_add_u32 s24, s24, 524288
buffer_atomic_add_f32 v10, v2, s[20:23], s24 offen
k3_wo_kernel_done:
s_endpgm
.globl k4_ffn1_kernel
.p2align 8
.type k4_ffn1_kernel,@function
k4_ffn1_kernel:
s_cmp_ge_u32 s2, 144
s_cbranch_scc1 k4_ffn1_kernel_done
s_load_dwordx2 s[4:5], s[0:1], 0
s_load_dwordx2 s[6:7], s[0:1], 48
s_load_dwordx2 s[8:9], s[0:1], 104
s_load_dwordx2 s[10:11], s[0:1], 56
s_waitcnt lgkmcnt(0)
s_mov_b32 s12, s4
s_and_b32 s13, s5, 0xffff
s_mov_b32 s14, 4608
s_mov_b32 s15, 0x00020000
s_mov_b32 s16, s6
s_and_b32 s17, s7, 0xffff
s_mov_b32 s18, 5308416
s_mov_b32 s19, 0x00020000
s_mov_b32 s20, s8
s_and_b32 s21, s9, 0xffff
s_mov_b32 s22, 536870912
s_mov_b32 s23, 0x00020000
s_mov_b32 s40, s10
s_and_b32 s41, s11, 0xffff
s_mov_b32 s42, 5308416
s_mov_b32 s43, 0x00020000
s_lshl_b32 s24, s2, 6
v_and_b32 v1, 63, v0
v_lshrrev_b32 v2, 6, v0
v_lshrrev_b32 v3, 2, v1
v_and_b32 v1, 3, v1
v_mad_u32_u24 v3, v2, 16, v3
s_mov_b32 s90, 9216
v_mul_lo_u32 v4, v3, s90
v_lshl_add_u32 v4, v1, 4, v4
s_mov_b32 s91, s24
buffer_load_dwordx4 v[160:163], v4, s[16:19], s91 offen
s_add_u32 s91, s91, 589824
buffer_load_dwordx4 v[164:167], v4, s[16:19], s91 offen
s_add_u32 s91, s91, 589824
buffer_load_dwordx4 v[168:171], v4, s[16:19], s91 offen
s_add_u32 s91, s91, 589824
buffer_load_dwordx4 v[172:175], v4, s[16:19], s91 offen
s_add_u32 s91, s91, 589824
buffer_load_dwordx4 v[176:179], v4, s[16:19], s91 offen
s_add_u32 s91, s91, 589824
buffer_load_dwordx4 v[180:183], v4, s[16:19], s91 offen
s_add_u32 s91, s91, 589824
buffer_load_dwordx4 v[184:187], v4, s[16:19], s91 offen
s_add_u32 s91, s91, 589824
buffer_load_dwordx4 v[188:191], v4, s[16:19], s91 offen
s_add_u32 s91, s91, 589824
buffer_load_dwordx4 v[192:195], v4, s[16:19], s91 offen
v_and_b32 v1, 63, v0
v_lshrrev_b32 v2, 6, v0
v_lshrrev_b32 v3, 2, v1
v_and_b32 v1, 3, v1
v_mad_u32_u24 v3, v2, 16, v3
s_mov_b32 s90, 9216
v_mul_lo_u32 v4, v3, s90
v_lshl_add_u32 v4, v1, 4, v4
s_mov_b32 s91, s24
buffer_load_dwordx4 v[196:199], v4, s[40:43], s91 offen
s_add_u32 s91, s91, 589824
buffer_load_dwordx4 v[200:203], v4, s[40:43], s91 offen
s_add_u32 s91, s91, 589824
buffer_load_dwordx4 v[204:207], v4, s[40:43], s91 offen
s_add_u32 s91, s91, 589824
buffer_load_dwordx4 v[208:211], v4, s[40:43], s91 offen
s_add_u32 s91, s91, 589824
buffer_load_dwordx4 v[212:215], v4, s[40:43], s91 offen
s_add_u32 s91, s91, 589824
buffer_load_dwordx4 v[216:219], v4, s[40:43], s91 offen
s_add_u32 s91, s91, 589824
buffer_load_dwordx4 v[220:223], v4, s[40:43], s91 offen
s_add_u32 s91, s91, 589824
buffer_load_dwordx4 v[224:227], v4, s[40:43], s91 offen
s_add_u32 s91, s91, 589824
buffer_load_dwordx4 v[228:231], v4, s[40:43], s91 offen
v_and_b32 v1, 63, v0
v_lshrrev_b32 v2, 6, v0
v_mul_u32_u24 v3, 576, v2
v_add_u32 v3, v3, v1
v_lshlrev_b32 v4, 1, v3
buffer_load_ushort v64, v4, s[12:15], 0 offen offset:0
buffer_load_ushort v65, v4, s[12:15], 0 offen offset:128
buffer_load_ushort v66, v4, s[12:15], 0 offen offset:256
buffer_load_ushort v67, v4, s[12:15], 0 offen offset:384
buffer_load_ushort v68, v4, s[12:15], 0 offen offset:512
buffer_load_ushort v69, v4, s[12:15], 0 offen offset:640
buffer_load_ushort v70, v4, s[12:15], 0 offen offset:768
buffer_load_ushort v71, v4, s[12:15], 0 offen offset:896
buffer_load_ushort v72, v4, s[12:15], 0 offen offset:1024
v_mul_u32_u24 v5, 3456, v2
v_add_u32 v5, v5, v1
v_lshlrev_b32 v5, 2, v5
s_mov_b32 s94, 9216
s_mov_b32 s95, 6912
s_mov_b32 s96, 4608
buffer_load_dword v80, v5, s[20:23], s94 offen offset:0
buffer_load_dword v96, v5, s[20:23], s95 offen offset:0
buffer_load_dword v81, v5, s[20:23], s94 offen offset:256
buffer_load_dword v97, v5, s[20:23], s95 offen offset:256
buffer_load_dword v82, v5, s[20:23], s94 offen offset:512
buffer_load_dword v98, v5, s[20:23], s95 offen offset:512
buffer_load_dword v83, v5, s[20:23], s94 offen offset:768
buffer_load_dword v99, v5, s[20:23], s95 offen offset:768
buffer_load_dword v84, v5, s[20:23], s94 offen offset:1024
buffer_load_dword v100, v5, s[20:23], s95 offen offset:1024
buffer_load_dword v85, v5, s[20:23], s94 offen offset:1280
buffer_load_dword v101, v5, s[20:23], s95 offen offset:1280
buffer_load_dword v86, v5, s[20:23], s94 offen offset:1536
buffer_load_dword v102, v5, s[20:23], s95 offen offset:1536
buffer_load_dword v87, v5, s[20:23], s94 offen offset:1792
buffer_load_dword v103, v5, s[20:23], s95 offen offset:1792
buffer_load_dword v88, v5, s[20:23], s94 offen offset:2048
buffer_load_dword v104, v5, s[20:23], s95 offen offset:2048
v_lshlrev_b32 v6, 2, v3
s_mov_b32 s92, 524288
buffer_load_dword v112, v6, s[20:23], s92 offen offset:0 sc0 sc1
buffer_load_dword v128, v5, s[20:23], s96 offen offset:0
buffer_load_dword v113, v6, s[20:23], s92 offen offset:256 sc0 sc1
buffer_load_dword v129, v5, s[20:23], s96 offen offset:256
buffer_load_dword v114, v6, s[20:23], s92 offen offset:512 sc0 sc1
buffer_load_dword v130, v5, s[20:23], s96 offen offset:512
buffer_load_dword v115, v6, s[20:23], s92 offen offset:768 sc0 sc1
buffer_load_dword v131, v5, s[20:23], s96 offen offset:768
buffer_load_dword v116, v6, s[20:23], s92 offen offset:1024 sc0 sc1
buffer_load_dword v132, v5, s[20:23], s96 offen offset:1024
buffer_load_dword v117, v6, s[20:23], s92 offen offset:1280 sc0 sc1
buffer_load_dword v133, v5, s[20:23], s96 offen offset:1280
buffer_load_dword v118, v6, s[20:23], s92 offen offset:1536 sc0 sc1
buffer_load_dword v134, v5, s[20:23], s96 offen offset:1536
buffer_load_dword v119, v6, s[20:23], s92 offen offset:1792 sc0 sc1
buffer_load_dword v135, v5, s[20:23], s96 offen offset:1792
buffer_load_dword v120, v6, s[20:23], s92 offen offset:2048 sc0 sc1
buffer_load_dword v136, v5, s[20:23], s96 offen offset:2048
s_waitcnt vmcnt(0)
v_lshlrev_b32 v64, 16, v64
v_cvt_pk_bf16_f32 v112, v112, v112
v_and_b32 v112, 0xffff0000, v112
v_mul_f32 v112, v112, v128
v_cvt_pk_bf16_f32 v112, v112, v112
v_and_b32 v112, 0xffff0000, v112
v_add_f32 v64, v64, v112
v_cvt_pk_bf16_f32 v64, v64, v64
v_and_b32 v64, 0xffff0000, v64
v_lshlrev_b32 v65, 16, v65
v_cvt_pk_bf16_f32 v113, v113, v113
v_and_b32 v113, 0xffff0000, v113
v_mul_f32 v113, v113, v129
v_cvt_pk_bf16_f32 v113, v113, v113
v_and_b32 v113, 0xffff0000, v113
v_add_f32 v65, v65, v113
v_cvt_pk_bf16_f32 v65, v65, v65
v_and_b32 v65, 0xffff0000, v65
v_lshlrev_b32 v66, 16, v66
v_cvt_pk_bf16_f32 v114, v114, v114
v_and_b32 v114, 0xffff0000, v114
v_mul_f32 v114, v114, v130
v_cvt_pk_bf16_f32 v114, v114, v114
v_and_b32 v114, 0xffff0000, v114
v_add_f32 v66, v66, v114
v_cvt_pk_bf16_f32 v66, v66, v66
v_and_b32 v66, 0xffff0000, v66
v_lshlrev_b32 v67, 16, v67
v_cvt_pk_bf16_f32 v115, v115, v115
v_and_b32 v115, 0xffff0000, v115
v_mul_f32 v115, v115, v131
v_cvt_pk_bf16_f32 v115, v115, v115
v_and_b32 v115, 0xffff0000, v115
v_add_f32 v67, v67, v115
v_cvt_pk_bf16_f32 v67, v67, v67
v_and_b32 v67, 0xffff0000, v67
v_lshlrev_b32 v68, 16, v68
v_cvt_pk_bf16_f32 v116, v116, v116
v_and_b32 v116, 0xffff0000, v116
v_mul_f32 v116, v116, v132
v_cvt_pk_bf16_f32 v116, v116, v116
v_and_b32 v116, 0xffff0000, v116
v_add_f32 v68, v68, v116
v_cvt_pk_bf16_f32 v68, v68, v68
v_and_b32 v68, 0xffff0000, v68
v_lshlrev_b32 v69, 16, v69
v_cvt_pk_bf16_f32 v117, v117, v117
v_and_b32 v117, 0xffff0000, v117
v_mul_f32 v117, v117, v133
v_cvt_pk_bf16_f32 v117, v117, v117
v_and_b32 v117, 0xffff0000, v117
v_add_f32 v69, v69, v117
v_cvt_pk_bf16_f32 v69, v69, v69
v_and_b32 v69, 0xffff0000, v69
v_lshlrev_b32 v70, 16, v70
v_cvt_pk_bf16_f32 v118, v118, v118
v_and_b32 v118, 0xffff0000, v118
v_mul_f32 v118, v118, v134
v_cvt_pk_bf16_f32 v118, v118, v118
v_and_b32 v118, 0xffff0000, v118
v_add_f32 v70, v70, v118
v_cvt_pk_bf16_f32 v70, v70, v70
v_and_b32 v70, 0xffff0000, v70
v_lshlrev_b32 v71, 16, v71
v_cvt_pk_bf16_f32 v119, v119, v119
v_and_b32 v119, 0xffff0000, v119
v_mul_f32 v119, v119, v135
v_cvt_pk_bf16_f32 v119, v119, v119
v_and_b32 v119, 0xffff0000, v119
v_add_f32 v71, v71, v119
v_cvt_pk_bf16_f32 v71, v71, v71
v_and_b32 v71, 0xffff0000, v71
v_lshlrev_b32 v72, 16, v72
v_cvt_pk_bf16_f32 v120, v120, v120
v_and_b32 v120, 0xffff0000, v120
v_mul_f32 v120, v120, v136
v_cvt_pk_bf16_f32 v120, v120, v120
v_and_b32 v120, 0xffff0000, v120
v_add_f32 v72, v72, v120
v_cvt_pk_bf16_f32 v72, v72, v72
v_and_b32 v72, 0xffff0000, v72
v_mov_b32 v7, 0
v_add_f32 v7, v7, v64
v_add_f32 v7, v7, v65
v_add_f32 v7, v7, v66
v_add_f32 v7, v7, v67
v_add_f32 v7, v7, v68
v_add_f32 v7, v7, v69
v_add_f32 v7, v7, v70
v_add_f32 v7, v7, v71
v_add_f32 v7, v7, v72
s_nop 1
v_add_f32_dpp v7, v7, v7 row_shr:1 row_mask:0xf bank_mask:0xf bound_ctrl:0
s_nop 1
v_add_f32_dpp v7, v7, v7 row_shr:2 row_mask:0xf bank_mask:0xf bound_ctrl:0
s_nop 1
v_add_f32_dpp v7, v7, v7 row_shr:4 row_mask:0xf bank_mask:0xf bound_ctrl:0
s_nop 1
v_add_f32_dpp v7, v7, v7 row_shr:8 row_mask:0xf bank_mask:0xf bound_ctrl:0
s_nop 1
v_add_f32_dpp v7, v7, v7 row_bcast:15 row_mask:0xa bank_mask:0xf
s_nop 1
v_add_f32_dpp v7, v7, v7 row_bcast:31 row_mask:0xc bank_mask:0xf
s_nop 1
v_readlane_b32 s93, v7, 63
s_nop 3
v_mov_b32 v7, 0x3ae38e39
v_mul_f32 v8, s93, v7
v_mov_b32 v9, 0
v_sub_f32 v6, v64, v8
v_fmac_f32 v9, v6, v6
v_sub_f32 v6, v65, v8
v_fmac_f32 v9, v6, v6
v_sub_f32 v6, v66, v8
v_fmac_f32 v9, v6, v6
v_sub_f32 v6, v67, v8
v_fmac_f32 v9, v6, v6
v_sub_f32 v6, v68, v8
v_fmac_f32 v9, v6, v6
v_sub_f32 v6, v69, v8
v_fmac_f32 v9, v6, v6
v_sub_f32 v6, v70, v8
v_fmac_f32 v9, v6, v6
v_sub_f32 v6, v71, v8
v_fmac_f32 v9, v6, v6
v_sub_f32 v6, v72, v8
v_fmac_f32 v9, v6, v6
s_nop 1
v_add_f32_dpp v9, v9, v9 row_shr:1 row_mask:0xf bank_mask:0xf bound_ctrl:0
s_nop 1
v_add_f32_dpp v9, v9, v9 row_shr:2 row_mask:0xf bank_mask:0xf bound_ctrl:0
s_nop 1
v_add_f32_dpp v9, v9, v9 row_shr:4 row_mask:0xf bank_mask:0xf bound_ctrl:0
s_nop 1
v_add_f32_dpp v9, v9, v9 row_shr:8 row_mask:0xf bank_mask:0xf bound_ctrl:0
s_nop 1
v_add_f32_dpp v9, v9, v9 row_bcast:15 row_mask:0xa bank_mask:0xf
s_nop 1
v_add_f32_dpp v9, v9, v9 row_bcast:31 row_mask:0xc bank_mask:0xf
s_nop 1
v_readlane_b32 s93, v9, 63
s_nop 3
v_mul_f32 v9, s93, v7
v_cvt_pk_bf16_f32 v9, v9, v9
v_and_b32 v9, 0xffff0000, v9
v_add_f32 v9, 0x3727c5ac, v9
v_cvt_pk_bf16_f32 v9, v9, v9
v_and_b32 v9, 0xffff0000, v9
v_sqrt_f32 v9, v9
s_nop 0
v_cvt_pk_bf16_f32 v9, v9, v9
v_and_b32 v9, 0xffff0000, v9
v_rcp_f32 v11, v9
v_cvt_pk_bf16_f32 v8, v8, v8
v_and_b32 v8, 0xffff0000, v8
v_lshlrev_b32 v4, 4, v1
v_lshl_add_u32 v4, v2, 2, v4
v_sub_f32 v64, v64, v8
v_cvt_pk_bf16_f32 v64, v64, v64
v_and_b32 v64, 0xffff0000, v64
v_mul_f32 v6, v64, v11
v_fma_f32 v7, -v6, v9, v64
v_fmac_f32 v6, v7, v11
v_cvt_pk_bf16_f32 v6, v6, v6
v_and_b32 v6, 0xffff0000, v6
v_add_f32 v7, 1.0, v80
v_cvt_pk_bf16_f32 v7, v7, v7
v_and_b32 v7, 0xffff0000, v7
v_mul_f32 v6, v6, v7
v_cvt_pk_bf16_f32 v6, v6, v6
v_and_b32 v6, 0xffff0000, v6
v_add_f32 v6, v6, v96
v_cvt_pk_bf16_f32 v6, v6, v6
v_and_b32 v6, 0xffff0000, v6
ds_write_b32 v4, v6 offset:0
v_sub_f32 v65, v65, v8
v_cvt_pk_bf16_f32 v65, v65, v65
v_and_b32 v65, 0xffff0000, v65
v_mul_f32 v6, v65, v11
v_fma_f32 v7, -v6, v9, v65
v_fmac_f32 v6, v7, v11
v_cvt_pk_bf16_f32 v6, v6, v6
v_and_b32 v6, 0xffff0000, v6
v_add_f32 v7, 1.0, v81
v_cvt_pk_bf16_f32 v7, v7, v7
v_and_b32 v7, 0xffff0000, v7
v_mul_f32 v6, v6, v7
v_cvt_pk_bf16_f32 v6, v6, v6
v_and_b32 v6, 0xffff0000, v6
v_add_f32 v6, v6, v97
v_cvt_pk_bf16_f32 v6, v6, v6
v_and_b32 v6, 0xffff0000, v6
ds_write_b32 v4, v6 offset:1024
v_sub_f32 v66, v66, v8
v_cvt_pk_bf16_f32 v66, v66, v66
v_and_b32 v66, 0xffff0000, v66
v_mul_f32 v6, v66, v11
v_fma_f32 v7, -v6, v9, v66
v_fmac_f32 v6, v7, v11
v_cvt_pk_bf16_f32 v6, v6, v6
v_and_b32 v6, 0xffff0000, v6
v_add_f32 v7, 1.0, v82
v_cvt_pk_bf16_f32 v7, v7, v7
v_and_b32 v7, 0xffff0000, v7
v_mul_f32 v6, v6, v7
v_cvt_pk_bf16_f32 v6, v6, v6
v_and_b32 v6, 0xffff0000, v6
v_add_f32 v6, v6, v98
v_cvt_pk_bf16_f32 v6, v6, v6
v_and_b32 v6, 0xffff0000, v6
ds_write_b32 v4, v6 offset:2048
v_sub_f32 v67, v67, v8
v_cvt_pk_bf16_f32 v67, v67, v67
v_and_b32 v67, 0xffff0000, v67
v_mul_f32 v6, v67, v11
v_fma_f32 v7, -v6, v9, v67
v_fmac_f32 v6, v7, v11
v_cvt_pk_bf16_f32 v6, v6, v6
v_and_b32 v6, 0xffff0000, v6
v_add_f32 v7, 1.0, v83
v_cvt_pk_bf16_f32 v7, v7, v7
v_and_b32 v7, 0xffff0000, v7
v_mul_f32 v6, v6, v7
v_cvt_pk_bf16_f32 v6, v6, v6
v_and_b32 v6, 0xffff0000, v6
v_add_f32 v6, v6, v99
v_cvt_pk_bf16_f32 v6, v6, v6
v_and_b32 v6, 0xffff0000, v6
ds_write_b32 v4, v6 offset:3072
v_sub_f32 v68, v68, v8
v_cvt_pk_bf16_f32 v68, v68, v68
v_and_b32 v68, 0xffff0000, v68
v_mul_f32 v6, v68, v11
v_fma_f32 v7, -v6, v9, v68
v_fmac_f32 v6, v7, v11
v_cvt_pk_bf16_f32 v6, v6, v6
v_and_b32 v6, 0xffff0000, v6
v_add_f32 v7, 1.0, v84
v_cvt_pk_bf16_f32 v7, v7, v7
v_and_b32 v7, 0xffff0000, v7
v_mul_f32 v6, v6, v7
v_cvt_pk_bf16_f32 v6, v6, v6
v_and_b32 v6, 0xffff0000, v6
v_add_f32 v6, v6, v100
v_cvt_pk_bf16_f32 v6, v6, v6
v_and_b32 v6, 0xffff0000, v6
ds_write_b32 v4, v6 offset:4096
v_sub_f32 v69, v69, v8
v_cvt_pk_bf16_f32 v69, v69, v69
v_and_b32 v69, 0xffff0000, v69
v_mul_f32 v6, v69, v11
v_fma_f32 v7, -v6, v9, v69
v_fmac_f32 v6, v7, v11
v_cvt_pk_bf16_f32 v6, v6, v6
v_and_b32 v6, 0xffff0000, v6
v_add_f32 v7, 1.0, v85
v_cvt_pk_bf16_f32 v7, v7, v7
v_and_b32 v7, 0xffff0000, v7
v_mul_f32 v6, v6, v7
v_cvt_pk_bf16_f32 v6, v6, v6
v_and_b32 v6, 0xffff0000, v6
v_add_f32 v6, v6, v101
v_cvt_pk_bf16_f32 v6, v6, v6
v_and_b32 v6, 0xffff0000, v6
ds_write_b32 v4, v6 offset:5120
v_sub_f32 v70, v70, v8
v_cvt_pk_bf16_f32 v70, v70, v70
v_and_b32 v70, 0xffff0000, v70
v_mul_f32 v6, v70, v11
v_fma_f32 v7, -v6, v9, v70
v_fmac_f32 v6, v7, v11
v_cvt_pk_bf16_f32 v6, v6, v6
v_and_b32 v6, 0xffff0000, v6
v_add_f32 v7, 1.0, v86
v_cvt_pk_bf16_f32 v7, v7, v7
v_and_b32 v7, 0xffff0000, v7
v_mul_f32 v6, v6, v7
v_cvt_pk_bf16_f32 v6, v6, v6
v_and_b32 v6, 0xffff0000, v6
v_add_f32 v6, v6, v102
v_cvt_pk_bf16_f32 v6, v6, v6
v_and_b32 v6, 0xffff0000, v6
ds_write_b32 v4, v6 offset:6144
v_sub_f32 v71, v71, v8
v_cvt_pk_bf16_f32 v71, v71, v71
v_and_b32 v71, 0xffff0000, v71
v_mul_f32 v6, v71, v11
v_fma_f32 v7, -v6, v9, v71
v_fmac_f32 v6, v7, v11
v_cvt_pk_bf16_f32 v6, v6, v6
v_and_b32 v6, 0xffff0000, v6
v_add_f32 v7, 1.0, v87
v_cvt_pk_bf16_f32 v7, v7, v7
v_and_b32 v7, 0xffff0000, v7
v_mul_f32 v6, v6, v7
v_cvt_pk_bf16_f32 v6, v6, v6
v_and_b32 v6, 0xffff0000, v6
v_add_f32 v6, v6, v103
v_cvt_pk_bf16_f32 v6, v6, v6
v_and_b32 v6, 0xffff0000, v6
ds_write_b32 v4, v6 offset:7168
v_sub_f32 v72, v72, v8
v_cvt_pk_bf16_f32 v72, v72, v72
v_and_b32 v72, 0xffff0000, v72
v_mul_f32 v6, v72, v11
v_fma_f32 v7, -v6, v9, v72
v_fmac_f32 v6, v7, v11
v_cvt_pk_bf16_f32 v6, v6, v6
v_and_b32 v6, 0xffff0000, v6
v_add_f32 v7, 1.0, v88
v_cvt_pk_bf16_f32 v7, v7, v7
v_and_b32 v7, 0xffff0000, v7
v_mul_f32 v6, v6, v7
v_cvt_pk_bf16_f32 v6, v6, v6
v_and_b32 v6, 0xffff0000, v6
v_add_f32 v6, v6, v104
v_cvt_pk_bf16_f32 v6, v6, v6
v_and_b32 v6, 0xffff0000, v6
ds_write_b32 v4, v6 offset:8192
s_waitcnt lgkmcnt(0)
s_barrier
s_lshl_b32 s24, s2, 6
v_and_b32 v1, 63, v0
v_lshrrev_b32 v2, 6, v0
v_lshrrev_b32 v3, 2, v1
v_and_b32 v1, 3, v1
v_mad_u32_u24 v3, v2, 16, v3
s_mov_b32 s90, 9216
v_mul_lo_u32 v4, v3, s90
v_lshl_add_u32 v4, v1, 4, v4
s_mov_b32 s91, s24
v_lshlrev_b32 v5, 4, v3
ds_read_b128 v[64:67], v5 offset:0
ds_read_b128 v[68:71], v5 offset:1024
ds_read_b128 v[72:75], v5 offset:2048
ds_read_b128 v[76:79], v5 offset:3072
ds_read_b128 v[80:83], v5 offset:4096
ds_read_b128 v[84:87], v5 offset:5120
ds_read_b128 v[88:91], v5 offset:6144
ds_read_b128 v[92:95], v5 offset:7168
ds_read_b128 v[96:99], v5 offset:8192
v_mov_b32 v32, 0
v_mov_b32 v33, 0
v_mov_b32 v34, 0
v_mov_b32 v35, 0
v_mov_b32 v36, 0
v_mov_b32 v37, 0
v_mov_b32 v38, 0
v_mov_b32 v39, 0
v_mov_b32 v40, 0
v_mov_b32 v41, 0
v_mov_b32 v42, 0
v_mov_b32 v43, 0
v_mov_b32 v44, 0
v_mov_b32 v45, 0
v_mov_b32 v46, 0
v_mov_b32 v47, 0
v_mov_b32 v48, 0
v_mov_b32 v49, 0
v_mov_b32 v50, 0
v_mov_b32 v51, 0
v_mov_b32 v52, 0
v_mov_b32 v53, 0
v_mov_b32 v54, 0
v_mov_b32 v55, 0
v_mov_b32 v56, 0
v_mov_b32 v57, 0
v_mov_b32 v58, 0
v_mov_b32 v59, 0
v_mov_b32 v60, 0
v_mov_b32 v61, 0
v_mov_b32 v62, 0
v_mov_b32 v63, 0
s_waitcnt lgkmcnt(0)
s_waitcnt vmcnt(17)
v_lshlrev_b32 v6, 16, v160
v_and_b32 v7, 0xffff0000, v160
v_fmac_f32 v32, v64, v6
v_fmac_f32 v33, v64, v7
v_fmac_f32 v40, v65, v6
v_fmac_f32 v41, v65, v7
v_fmac_f32 v48, v66, v6
v_fmac_f32 v49, v66, v7
v_fmac_f32 v56, v67, v6
v_fmac_f32 v57, v67, v7
v_lshlrev_b32 v6, 16, v161
v_and_b32 v7, 0xffff0000, v161
v_fmac_f32 v34, v64, v6
v_fmac_f32 v35, v64, v7
v_fmac_f32 v42, v65, v6
v_fmac_f32 v43, v65, v7
v_fmac_f32 v50, v66, v6
v_fmac_f32 v51, v66, v7
v_fmac_f32 v58, v67, v6
v_fmac_f32 v59, v67, v7
v_lshlrev_b32 v6, 16, v162
v_and_b32 v7, 0xffff0000, v162
v_fmac_f32 v36, v64, v6
v_fmac_f32 v37, v64, v7
v_fmac_f32 v44, v65, v6
v_fmac_f32 v45, v65, v7
v_fmac_f32 v52, v66, v6
v_fmac_f32 v53, v66, v7
v_fmac_f32 v60, v67, v6
v_fmac_f32 v61, v67, v7
v_lshlrev_b32 v6, 16, v163
v_and_b32 v7, 0xffff0000, v163
v_fmac_f32 v38, v64, v6
v_fmac_f32 v39, v64, v7
v_fmac_f32 v46, v65, v6
v_fmac_f32 v47, v65, v7
v_fmac_f32 v54, v66, v6
v_fmac_f32 v55, v66, v7
v_fmac_f32 v62, v67, v6
v_fmac_f32 v63, v67, v7
s_waitcnt vmcnt(16)
v_lshlrev_b32 v6, 16, v164
v_and_b32 v7, 0xffff0000, v164
v_fmac_f32 v32, v68, v6
v_fmac_f32 v33, v68, v7
v_fmac_f32 v40, v69, v6
v_fmac_f32 v41, v69, v7
v_fmac_f32 v48, v70, v6
v_fmac_f32 v49, v70, v7
v_fmac_f32 v56, v71, v6
v_fmac_f32 v57, v71, v7
v_lshlrev_b32 v6, 16, v165
v_and_b32 v7, 0xffff0000, v165
v_fmac_f32 v34, v68, v6
v_fmac_f32 v35, v68, v7
v_fmac_f32 v42, v69, v6
v_fmac_f32 v43, v69, v7
v_fmac_f32 v50, v70, v6
v_fmac_f32 v51, v70, v7
v_fmac_f32 v58, v71, v6
v_fmac_f32 v59, v71, v7
v_lshlrev_b32 v6, 16, v166
v_and_b32 v7, 0xffff0000, v166
v_fmac_f32 v36, v68, v6
v_fmac_f32 v37, v68, v7
v_fmac_f32 v44, v69, v6
v_fmac_f32 v45, v69, v7
v_fmac_f32 v52, v70, v6
v_fmac_f32 v53, v70, v7
v_fmac_f32 v60, v71, v6
v_fmac_f32 v61, v71, v7
v_lshlrev_b32 v6, 16, v167
v_and_b32 v7, 0xffff0000, v167
v_fmac_f32 v38, v68, v6
v_fmac_f32 v39, v68, v7
v_fmac_f32 v46, v69, v6
v_fmac_f32 v47, v69, v7
v_fmac_f32 v54, v70, v6
v_fmac_f32 v55, v70, v7
v_fmac_f32 v62, v71, v6
v_fmac_f32 v63, v71, v7
s_waitcnt vmcnt(15)
v_lshlrev_b32 v6, 16, v168
v_and_b32 v7, 0xffff0000, v168
v_fmac_f32 v32, v72, v6
v_fmac_f32 v33, v72, v7
v_fmac_f32 v40, v73, v6
v_fmac_f32 v41, v73, v7
v_fmac_f32 v48, v74, v6
v_fmac_f32 v49, v74, v7
v_fmac_f32 v56, v75, v6
v_fmac_f32 v57, v75, v7
v_lshlrev_b32 v6, 16, v169
v_and_b32 v7, 0xffff0000, v169
v_fmac_f32 v34, v72, v6
v_fmac_f32 v35, v72, v7
v_fmac_f32 v42, v73, v6
v_fmac_f32 v43, v73, v7
v_fmac_f32 v50, v74, v6
v_fmac_f32 v51, v74, v7
v_fmac_f32 v58, v75, v6
v_fmac_f32 v59, v75, v7
v_lshlrev_b32 v6, 16, v170
v_and_b32 v7, 0xffff0000, v170
v_fmac_f32 v36, v72, v6
v_fmac_f32 v37, v72, v7
v_fmac_f32 v44, v73, v6
v_fmac_f32 v45, v73, v7
v_fmac_f32 v52, v74, v6
v_fmac_f32 v53, v74, v7
v_fmac_f32 v60, v75, v6
v_fmac_f32 v61, v75, v7
v_lshlrev_b32 v6, 16, v171
v_and_b32 v7, 0xffff0000, v171
v_fmac_f32 v38, v72, v6
v_fmac_f32 v39, v72, v7
v_fmac_f32 v46, v73, v6
v_fmac_f32 v47, v73, v7
v_fmac_f32 v54, v74, v6
v_fmac_f32 v55, v74, v7
v_fmac_f32 v62, v75, v6
v_fmac_f32 v63, v75, v7
s_waitcnt vmcnt(14)
v_lshlrev_b32 v6, 16, v172
v_and_b32 v7, 0xffff0000, v172
v_fmac_f32 v32, v76, v6
v_fmac_f32 v33, v76, v7
v_fmac_f32 v40, v77, v6
v_fmac_f32 v41, v77, v7
v_fmac_f32 v48, v78, v6
v_fmac_f32 v49, v78, v7
v_fmac_f32 v56, v79, v6
v_fmac_f32 v57, v79, v7
v_lshlrev_b32 v6, 16, v173
v_and_b32 v7, 0xffff0000, v173
v_fmac_f32 v34, v76, v6
v_fmac_f32 v35, v76, v7
v_fmac_f32 v42, v77, v6
v_fmac_f32 v43, v77, v7
v_fmac_f32 v50, v78, v6
v_fmac_f32 v51, v78, v7
v_fmac_f32 v58, v79, v6
v_fmac_f32 v59, v79, v7
v_lshlrev_b32 v6, 16, v174
v_and_b32 v7, 0xffff0000, v174
v_fmac_f32 v36, v76, v6
v_fmac_f32 v37, v76, v7
v_fmac_f32 v44, v77, v6
v_fmac_f32 v45, v77, v7
v_fmac_f32 v52, v78, v6
v_fmac_f32 v53, v78, v7
v_fmac_f32 v60, v79, v6
v_fmac_f32 v61, v79, v7
v_lshlrev_b32 v6, 16, v175
v_and_b32 v7, 0xffff0000, v175
v_fmac_f32 v38, v76, v6
v_fmac_f32 v39, v76, v7
v_fmac_f32 v46, v77, v6
v_fmac_f32 v47, v77, v7
v_fmac_f32 v54, v78, v6
v_fmac_f32 v55, v78, v7
v_fmac_f32 v62, v79, v6
v_fmac_f32 v63, v79, v7
s_waitcnt vmcnt(13)
v_lshlrev_b32 v6, 16, v176
v_and_b32 v7, 0xffff0000, v176
v_fmac_f32 v32, v80, v6
v_fmac_f32 v33, v80, v7
v_fmac_f32 v40, v81, v6
v_fmac_f32 v41, v81, v7
v_fmac_f32 v48, v82, v6
v_fmac_f32 v49, v82, v7
v_fmac_f32 v56, v83, v6
v_fmac_f32 v57, v83, v7
v_lshlrev_b32 v6, 16, v177
v_and_b32 v7, 0xffff0000, v177
v_fmac_f32 v34, v80, v6
v_fmac_f32 v35, v80, v7
v_fmac_f32 v42, v81, v6
v_fmac_f32 v43, v81, v7
v_fmac_f32 v50, v82, v6
v_fmac_f32 v51, v82, v7
v_fmac_f32 v58, v83, v6
v_fmac_f32 v59, v83, v7
v_lshlrev_b32 v6, 16, v178
v_and_b32 v7, 0xffff0000, v178
v_fmac_f32 v36, v80, v6
v_fmac_f32 v37, v80, v7
v_fmac_f32 v44, v81, v6
v_fmac_f32 v45, v81, v7
v_fmac_f32 v52, v82, v6
v_fmac_f32 v53, v82, v7
v_fmac_f32 v60, v83, v6
v_fmac_f32 v61, v83, v7
v_lshlrev_b32 v6, 16, v179
v_and_b32 v7, 0xffff0000, v179
v_fmac_f32 v38, v80, v6
v_fmac_f32 v39, v80, v7
v_fmac_f32 v46, v81, v6
v_fmac_f32 v47, v81, v7
v_fmac_f32 v54, v82, v6
v_fmac_f32 v55, v82, v7
v_fmac_f32 v62, v83, v6
v_fmac_f32 v63, v83, v7
s_waitcnt vmcnt(12)
v_lshlrev_b32 v6, 16, v180
v_and_b32 v7, 0xffff0000, v180
v_fmac_f32 v32, v84, v6
v_fmac_f32 v33, v84, v7
v_fmac_f32 v40, v85, v6
v_fmac_f32 v41, v85, v7
v_fmac_f32 v48, v86, v6
v_fmac_f32 v49, v86, v7
v_fmac_f32 v56, v87, v6
v_fmac_f32 v57, v87, v7
v_lshlrev_b32 v6, 16, v181
v_and_b32 v7, 0xffff0000, v181
v_fmac_f32 v34, v84, v6
v_fmac_f32 v35, v84, v7
v_fmac_f32 v42, v85, v6
v_fmac_f32 v43, v85, v7
v_fmac_f32 v50, v86, v6
v_fmac_f32 v51, v86, v7
v_fmac_f32 v58, v87, v6
v_fmac_f32 v59, v87, v7
v_lshlrev_b32 v6, 16, v182
v_and_b32 v7, 0xffff0000, v182
v_fmac_f32 v36, v84, v6
v_fmac_f32 v37, v84, v7
v_fmac_f32 v44, v85, v6
v_fmac_f32 v45, v85, v7
v_fmac_f32 v52, v86, v6
v_fmac_f32 v53, v86, v7
v_fmac_f32 v60, v87, v6
v_fmac_f32 v61, v87, v7
v_lshlrev_b32 v6, 16, v183
v_and_b32 v7, 0xffff0000, v183
v_fmac_f32 v38, v84, v6
v_fmac_f32 v39, v84, v7
v_fmac_f32 v46, v85, v6
v_fmac_f32 v47, v85, v7
v_fmac_f32 v54, v86, v6
v_fmac_f32 v55, v86, v7
v_fmac_f32 v62, v87, v6
v_fmac_f32 v63, v87, v7
s_waitcnt vmcnt(11)
v_lshlrev_b32 v6, 16, v184
v_and_b32 v7, 0xffff0000, v184
v_fmac_f32 v32, v88, v6
v_fmac_f32 v33, v88, v7
v_fmac_f32 v40, v89, v6
v_fmac_f32 v41, v89, v7
v_fmac_f32 v48, v90, v6
v_fmac_f32 v49, v90, v7
v_fmac_f32 v56, v91, v6
v_fmac_f32 v57, v91, v7
v_lshlrev_b32 v6, 16, v185
v_and_b32 v7, 0xffff0000, v185
v_fmac_f32 v34, v88, v6
v_fmac_f32 v35, v88, v7
v_fmac_f32 v42, v89, v6
v_fmac_f32 v43, v89, v7
v_fmac_f32 v50, v90, v6
v_fmac_f32 v51, v90, v7
v_fmac_f32 v58, v91, v6
v_fmac_f32 v59, v91, v7
v_lshlrev_b32 v6, 16, v186
v_and_b32 v7, 0xffff0000, v186
v_fmac_f32 v36, v88, v6
v_fmac_f32 v37, v88, v7
v_fmac_f32 v44, v89, v6
v_fmac_f32 v45, v89, v7
v_fmac_f32 v52, v90, v6
v_fmac_f32 v53, v90, v7
v_fmac_f32 v60, v91, v6
v_fmac_f32 v61, v91, v7
v_lshlrev_b32 v6, 16, v187
v_and_b32 v7, 0xffff0000, v187
v_fmac_f32 v38, v88, v6
v_fmac_f32 v39, v88, v7
v_fmac_f32 v46, v89, v6
v_fmac_f32 v47, v89, v7
v_fmac_f32 v54, v90, v6
v_fmac_f32 v55, v90, v7
v_fmac_f32 v62, v91, v6
v_fmac_f32 v63, v91, v7
s_waitcnt vmcnt(10)
v_lshlrev_b32 v6, 16, v188
v_and_b32 v7, 0xffff0000, v188
v_fmac_f32 v32, v92, v6
v_fmac_f32 v33, v92, v7
v_fmac_f32 v40, v93, v6
v_fmac_f32 v41, v93, v7
v_fmac_f32 v48, v94, v6
v_fmac_f32 v49, v94, v7
v_fmac_f32 v56, v95, v6
v_fmac_f32 v57, v95, v7
v_lshlrev_b32 v6, 16, v189
v_and_b32 v7, 0xffff0000, v189
v_fmac_f32 v34, v92, v6
v_fmac_f32 v35, v92, v7
v_fmac_f32 v42, v93, v6
v_fmac_f32 v43, v93, v7
v_fmac_f32 v50, v94, v6
v_fmac_f32 v51, v94, v7
v_fmac_f32 v58, v95, v6
v_fmac_f32 v59, v95, v7
v_lshlrev_b32 v6, 16, v190
v_and_b32 v7, 0xffff0000, v190
v_fmac_f32 v36, v92, v6
v_fmac_f32 v37, v92, v7
v_fmac_f32 v44, v93, v6
v_fmac_f32 v45, v93, v7
v_fmac_f32 v52, v94, v6
v_fmac_f32 v53, v94, v7
v_fmac_f32 v60, v95, v6
v_fmac_f32 v61, v95, v7
v_lshlrev_b32 v6, 16, v191
v_and_b32 v7, 0xffff0000, v191
v_fmac_f32 v38, v92, v6
v_fmac_f32 v39, v92, v7
v_fmac_f32 v46, v93, v6
v_fmac_f32 v47, v93, v7
v_fmac_f32 v54, v94, v6
v_fmac_f32 v55, v94, v7
v_fmac_f32 v62, v95, v6
v_fmac_f32 v63, v95, v7
s_waitcnt vmcnt(9)
v_lshlrev_b32 v6, 16, v192
v_and_b32 v7, 0xffff0000, v192
v_fmac_f32 v32, v96, v6
v_fmac_f32 v33, v96, v7
v_fmac_f32 v40, v97, v6
v_fmac_f32 v41, v97, v7
v_fmac_f32 v48, v98, v6
v_fmac_f32 v49, v98, v7
v_fmac_f32 v56, v99, v6
v_fmac_f32 v57, v99, v7
v_lshlrev_b32 v6, 16, v193
v_and_b32 v7, 0xffff0000, v193
v_fmac_f32 v34, v96, v6
v_fmac_f32 v35, v96, v7
v_fmac_f32 v42, v97, v6
v_fmac_f32 v43, v97, v7
v_fmac_f32 v50, v98, v6
v_fmac_f32 v51, v98, v7
v_fmac_f32 v58, v99, v6
v_fmac_f32 v59, v99, v7
v_lshlrev_b32 v6, 16, v194
v_and_b32 v7, 0xffff0000, v194
v_fmac_f32 v36, v96, v6
v_fmac_f32 v37, v96, v7
v_fmac_f32 v44, v97, v6
v_fmac_f32 v45, v97, v7
v_fmac_f32 v52, v98, v6
v_fmac_f32 v53, v98, v7
v_fmac_f32 v60, v99, v6
v_fmac_f32 v61, v99, v7
v_lshlrev_b32 v6, 16, v195
v_and_b32 v7, 0xffff0000, v195
v_fmac_f32 v38, v96, v6
v_fmac_f32 v39, v96, v7
v_fmac_f32 v46, v97, v6
v_fmac_f32 v47, v97, v7
v_fmac_f32 v54, v98, v6
v_fmac_f32 v55, v98, v7
v_fmac_f32 v62, v99, v6
v_fmac_f32 v63, v99, v7
v_mul_u32_u24 v5, 512, v3
v_lshl_add_u32 v5, v1, 5, v5
ds_write_b128 v5, v[32:35] offset:16384
ds_write_b128 v5, v[36:39] offset:16400
ds_write_b128 v5, v[40:43] offset:16512
ds_write_b128 v5, v[44:47] offset:16528
ds_write_b128 v5, v[48:51] offset:16640
ds_write_b128 v5, v[52:55] offset:16656
ds_write_b128 v5, v[56:59] offset:16768
ds_write_b128 v5, v[60:63] offset:16784
s_waitcnt lgkmcnt(0)
s_barrier
v_lshlrev_b32 v5, 2, v0
v_mov_b32 v10, 0
ds_read_b32 v64, v5 offset:16384
ds_read_b32 v65, v5 offset:16896
ds_read_b32 v66, v5 offset:17408
ds_read_b32 v67, v5 offset:17920
ds_read_b32 v68, v5 offset:18432
ds_read_b32 v69, v5 offset:18944
ds_read_b32 v70, v5 offset:19456
ds_read_b32 v71, v5 offset:19968
ds_read_b32 v72, v5 offset:20480
ds_read_b32 v73, v5 offset:20992
ds_read_b32 v74, v5 offset:21504
ds_read_b32 v75, v5 offset:22016
ds_read_b32 v76, v5 offset:22528
ds_read_b32 v77, v5 offset:23040
ds_read_b32 v78, v5 offset:23552
ds_read_b32 v79, v5 offset:24064
s_waitcnt lgkmcnt(0)
v_add_f32 v10, v10, v64
v_add_f32 v10, v10, v65
v_add_f32 v10, v10, v66
v_add_f32 v10, v10, v67
v_add_f32 v10, v10, v68
v_add_f32 v10, v10, v69
v_add_f32 v10, v10, v70
v_add_f32 v10, v10, v71
v_add_f32 v10, v10, v72
v_add_f32 v10, v10, v73
v_add_f32 v10, v10, v74
v_add_f32 v10, v10, v75
v_add_f32 v10, v10, v76
v_add_f32 v10, v10, v77
v_add_f32 v10, v10, v78
v_add_f32 v10, v10, v79
ds_read_b32 v64, v5 offset:24576
ds_read_b32 v65, v5 offset:25088
ds_read_b32 v66, v5 offset:25600
ds_read_b32 v67, v5 offset:26112
ds_read_b32 v68, v5 offset:26624
ds_read_b32 v69, v5 offset:27136
ds_read_b32 v70, v5 offset:27648
ds_read_b32 v71, v5 offset:28160
ds_read_b32 v72, v5 offset:28672
ds_read_b32 v73, v5 offset:29184
ds_read_b32 v74, v5 offset:29696
ds_read_b32 v75, v5 offset:30208
ds_read_b32 v76, v5 offset:30720
ds_read_b32 v77, v5 offset:31232
ds_read_b32 v78, v5 offset:31744
ds_read_b32 v79, v5 offset:32256
s_waitcnt lgkmcnt(0)
v_add_f32 v10, v10, v64
v_add_f32 v10, v10, v65
v_add_f32 v10, v10, v66
v_add_f32 v10, v10, v67
v_add_f32 v10, v10, v68
v_add_f32 v10, v10, v69
v_add_f32 v10, v10, v70
v_add_f32 v10, v10, v71
v_add_f32 v10, v10, v72
v_add_f32 v10, v10, v73
v_add_f32 v10, v10, v74
v_add_f32 v10, v10, v75
v_add_f32 v10, v10, v76
v_add_f32 v10, v10, v77
v_add_f32 v10, v10, v78
v_add_f32 v10, v10, v79
ds_read_b32 v64, v5 offset:32768
ds_read_b32 v65, v5 offset:33280
ds_read_b32 v66, v5 offset:33792
ds_read_b32 v67, v5 offset:34304
ds_read_b32 v68, v5 offset:34816
ds_read_b32 v69, v5 offset:35328
ds_read_b32 v70, v5 offset:35840
ds_read_b32 v71, v5 offset:36352
ds_read_b32 v72, v5 offset:36864
ds_read_b32 v73, v5 offset:37376
ds_read_b32 v74, v5 offset:37888
ds_read_b32 v75, v5 offset:38400
ds_read_b32 v76, v5 offset:38912
ds_read_b32 v77, v5 offset:39424
ds_read_b32 v78, v5 offset:39936
ds_read_b32 v79, v5 offset:40448
s_waitcnt lgkmcnt(0)
v_add_f32 v10, v10, v64
v_add_f32 v10, v10, v65
v_add_f32 v10, v10, v66
v_add_f32 v10, v10, v67
v_add_f32 v10, v10, v68
v_add_f32 v10, v10, v69
v_add_f32 v10, v10, v70
v_add_f32 v10, v10, v71
v_add_f32 v10, v10, v72
v_add_f32 v10, v10, v73
v_add_f32 v10, v10, v74
v_add_f32 v10, v10, v75
v_add_f32 v10, v10, v76
v_add_f32 v10, v10, v77
v_add_f32 v10, v10, v78
v_add_f32 v10, v10, v79
ds_read_b32 v64, v5 offset:40960
ds_read_b32 v65, v5 offset:41472
ds_read_b32 v66, v5 offset:41984
ds_read_b32 v67, v5 offset:42496
ds_read_b32 v68, v5 offset:43008
ds_read_b32 v69, v5 offset:43520
ds_read_b32 v70, v5 offset:44032
ds_read_b32 v71, v5 offset:44544
ds_read_b32 v72, v5 offset:45056
ds_read_b32 v73, v5 offset:45568
ds_read_b32 v74, v5 offset:46080
ds_read_b32 v75, v5 offset:46592
ds_read_b32 v76, v5 offset:47104
ds_read_b32 v77, v5 offset:47616
ds_read_b32 v78, v5 offset:48128
ds_read_b32 v79, v5 offset:48640
s_waitcnt lgkmcnt(0)
v_add_f32 v10, v10, v64
v_add_f32 v10, v10, v65
v_add_f32 v10, v10, v66
v_add_f32 v10, v10, v67
v_add_f32 v10, v10, v68
v_add_f32 v10, v10, v69
v_add_f32 v10, v10, v70
v_add_f32 v10, v10, v71
v_add_f32 v10, v10, v72
v_add_f32 v10, v10, v73
v_add_f32 v10, v10, v74
v_add_f32 v10, v10, v75
v_add_f32 v10, v10, v76
v_add_f32 v10, v10, v77
v_add_f32 v10, v10, v78
v_add_f32 v10, v10, v79
v_mov_b32 v240, v10
s_barrier
v_and_b32 v1, 63, v0
v_lshrrev_b32 v2, 6, v0
v_lshrrev_b32 v3, 2, v1
v_and_b32 v1, 3, v1
v_mad_u32_u24 v3, v2, 16, v3
s_mov_b32 s90, 9216
v_mul_lo_u32 v4, v3, s90
v_lshl_add_u32 v4, v1, 4, v4
s_mov_b32 s91, s24
v_lshlrev_b32 v5, 4, v3
ds_read_b128 v[64:67], v5 offset:0
ds_read_b128 v[68:71], v5 offset:1024
ds_read_b128 v[72:75], v5 offset:2048
ds_read_b128 v[76:79], v5 offset:3072
ds_read_b128 v[80:83], v5 offset:4096
ds_read_b128 v[84:87], v5 offset:5120
ds_read_b128 v[88:91], v5 offset:6144
ds_read_b128 v[92:95], v5 offset:7168
ds_read_b128 v[96:99], v5 offset:8192
v_mov_b32 v32, 0
v_mov_b32 v33, 0
v_mov_b32 v34, 0
v_mov_b32 v35, 0
v_mov_b32 v36, 0
v_mov_b32 v37, 0
v_mov_b32 v38, 0
v_mov_b32 v39, 0
v_mov_b32 v40, 0
v_mov_b32 v41, 0
v_mov_b32 v42, 0
v_mov_b32 v43, 0
v_mov_b32 v44, 0
v_mov_b32 v45, 0
v_mov_b32 v46, 0
v_mov_b32 v47, 0
v_mov_b32 v48, 0
v_mov_b32 v49, 0
v_mov_b32 v50, 0
v_mov_b32 v51, 0
v_mov_b32 v52, 0
v_mov_b32 v53, 0
v_mov_b32 v54, 0
v_mov_b32 v55, 0
v_mov_b32 v56, 0
v_mov_b32 v57, 0
v_mov_b32 v58, 0
v_mov_b32 v59, 0
v_mov_b32 v60, 0
v_mov_b32 v61, 0
v_mov_b32 v62, 0
v_mov_b32 v63, 0
s_waitcnt lgkmcnt(0)
s_waitcnt vmcnt(8)
v_lshlrev_b32 v6, 16, v196
v_and_b32 v7, 0xffff0000, v196
v_fmac_f32 v32, v64, v6
v_fmac_f32 v33, v64, v7
v_fmac_f32 v40, v65, v6
v_fmac_f32 v41, v65, v7
v_fmac_f32 v48, v66, v6
v_fmac_f32 v49, v66, v7
v_fmac_f32 v56, v67, v6
v_fmac_f32 v57, v67, v7
v_lshlrev_b32 v6, 16, v197
v_and_b32 v7, 0xffff0000, v197
v_fmac_f32 v34, v64, v6
v_fmac_f32 v35, v64, v7
v_fmac_f32 v42, v65, v6
v_fmac_f32 v43, v65, v7
v_fmac_f32 v50, v66, v6
v_fmac_f32 v51, v66, v7
v_fmac_f32 v58, v67, v6
v_fmac_f32 v59, v67, v7
v_lshlrev_b32 v6, 16, v198
v_and_b32 v7, 0xffff0000, v198
v_fmac_f32 v36, v64, v6
v_fmac_f32 v37, v64, v7
v_fmac_f32 v44, v65, v6
v_fmac_f32 v45, v65, v7
v_fmac_f32 v52, v66, v6
v_fmac_f32 v53, v66, v7
v_fmac_f32 v60, v67, v6
v_fmac_f32 v61, v67, v7
v_lshlrev_b32 v6, 16, v199
v_and_b32 v7, 0xffff0000, v199
v_fmac_f32 v38, v64, v6
v_fmac_f32 v39, v64, v7
v_fmac_f32 v46, v65, v6
v_fmac_f32 v47, v65, v7
v_fmac_f32 v54, v66, v6
v_fmac_f32 v55, v66, v7
v_fmac_f32 v62, v67, v6
v_fmac_f32 v63, v67, v7
s_waitcnt vmcnt(7)
v_lshlrev_b32 v6, 16, v200
v_and_b32 v7, 0xffff0000, v200
v_fmac_f32 v32, v68, v6
v_fmac_f32 v33, v68, v7
v_fmac_f32 v40, v69, v6
v_fmac_f32 v41, v69, v7
v_fmac_f32 v48, v70, v6
v_fmac_f32 v49, v70, v7
v_fmac_f32 v56, v71, v6
v_fmac_f32 v57, v71, v7
v_lshlrev_b32 v6, 16, v201
v_and_b32 v7, 0xffff0000, v201
v_fmac_f32 v34, v68, v6
v_fmac_f32 v35, v68, v7
v_fmac_f32 v42, v69, v6
v_fmac_f32 v43, v69, v7
v_fmac_f32 v50, v70, v6
v_fmac_f32 v51, v70, v7
v_fmac_f32 v58, v71, v6
v_fmac_f32 v59, v71, v7
v_lshlrev_b32 v6, 16, v202
v_and_b32 v7, 0xffff0000, v202
v_fmac_f32 v36, v68, v6
v_fmac_f32 v37, v68, v7
v_fmac_f32 v44, v69, v6
v_fmac_f32 v45, v69, v7
v_fmac_f32 v52, v70, v6
v_fmac_f32 v53, v70, v7
v_fmac_f32 v60, v71, v6
v_fmac_f32 v61, v71, v7
v_lshlrev_b32 v6, 16, v203
v_and_b32 v7, 0xffff0000, v203
v_fmac_f32 v38, v68, v6
v_fmac_f32 v39, v68, v7
v_fmac_f32 v46, v69, v6
v_fmac_f32 v47, v69, v7
v_fmac_f32 v54, v70, v6
v_fmac_f32 v55, v70, v7
v_fmac_f32 v62, v71, v6
v_fmac_f32 v63, v71, v7
s_waitcnt vmcnt(6)
v_lshlrev_b32 v6, 16, v204
v_and_b32 v7, 0xffff0000, v204
v_fmac_f32 v32, v72, v6
v_fmac_f32 v33, v72, v7
v_fmac_f32 v40, v73, v6
v_fmac_f32 v41, v73, v7
v_fmac_f32 v48, v74, v6
v_fmac_f32 v49, v74, v7
v_fmac_f32 v56, v75, v6
v_fmac_f32 v57, v75, v7
v_lshlrev_b32 v6, 16, v205
v_and_b32 v7, 0xffff0000, v205
v_fmac_f32 v34, v72, v6
v_fmac_f32 v35, v72, v7
v_fmac_f32 v42, v73, v6
v_fmac_f32 v43, v73, v7
v_fmac_f32 v50, v74, v6
v_fmac_f32 v51, v74, v7
v_fmac_f32 v58, v75, v6
v_fmac_f32 v59, v75, v7
v_lshlrev_b32 v6, 16, v206
v_and_b32 v7, 0xffff0000, v206
v_fmac_f32 v36, v72, v6
v_fmac_f32 v37, v72, v7
v_fmac_f32 v44, v73, v6
v_fmac_f32 v45, v73, v7
v_fmac_f32 v52, v74, v6
v_fmac_f32 v53, v74, v7
v_fmac_f32 v60, v75, v6
v_fmac_f32 v61, v75, v7
v_lshlrev_b32 v6, 16, v207
v_and_b32 v7, 0xffff0000, v207
v_fmac_f32 v38, v72, v6
v_fmac_f32 v39, v72, v7
v_fmac_f32 v46, v73, v6
v_fmac_f32 v47, v73, v7
v_fmac_f32 v54, v74, v6
v_fmac_f32 v55, v74, v7
v_fmac_f32 v62, v75, v6
v_fmac_f32 v63, v75, v7
s_waitcnt vmcnt(5)
v_lshlrev_b32 v6, 16, v208
v_and_b32 v7, 0xffff0000, v208
v_fmac_f32 v32, v76, v6
v_fmac_f32 v33, v76, v7
v_fmac_f32 v40, v77, v6
v_fmac_f32 v41, v77, v7
v_fmac_f32 v48, v78, v6
v_fmac_f32 v49, v78, v7
v_fmac_f32 v56, v79, v6
v_fmac_f32 v57, v79, v7
v_lshlrev_b32 v6, 16, v209
v_and_b32 v7, 0xffff0000, v209
v_fmac_f32 v34, v76, v6
v_fmac_f32 v35, v76, v7
v_fmac_f32 v42, v77, v6
v_fmac_f32 v43, v77, v7
v_fmac_f32 v50, v78, v6
v_fmac_f32 v51, v78, v7
v_fmac_f32 v58, v79, v6
v_fmac_f32 v59, v79, v7
v_lshlrev_b32 v6, 16, v210
v_and_b32 v7, 0xffff0000, v210
v_fmac_f32 v36, v76, v6
v_fmac_f32 v37, v76, v7
v_fmac_f32 v44, v77, v6
v_fmac_f32 v45, v77, v7
v_fmac_f32 v52, v78, v6
v_fmac_f32 v53, v78, v7
v_fmac_f32 v60, v79, v6
v_fmac_f32 v61, v79, v7
v_lshlrev_b32 v6, 16, v211
v_and_b32 v7, 0xffff0000, v211
v_fmac_f32 v38, v76, v6
v_fmac_f32 v39, v76, v7
v_fmac_f32 v46, v77, v6
v_fmac_f32 v47, v77, v7
v_fmac_f32 v54, v78, v6
v_fmac_f32 v55, v78, v7
v_fmac_f32 v62, v79, v6
v_fmac_f32 v63, v79, v7
s_waitcnt vmcnt(4)
v_lshlrev_b32 v6, 16, v212
v_and_b32 v7, 0xffff0000, v212
v_fmac_f32 v32, v80, v6
v_fmac_f32 v33, v80, v7
v_fmac_f32 v40, v81, v6
v_fmac_f32 v41, v81, v7
v_fmac_f32 v48, v82, v6
v_fmac_f32 v49, v82, v7
v_fmac_f32 v56, v83, v6
v_fmac_f32 v57, v83, v7
v_lshlrev_b32 v6, 16, v213
v_and_b32 v7, 0xffff0000, v213
v_fmac_f32 v34, v80, v6
v_fmac_f32 v35, v80, v7
v_fmac_f32 v42, v81, v6
v_fmac_f32 v43, v81, v7
v_fmac_f32 v50, v82, v6
v_fmac_f32 v51, v82, v7
v_fmac_f32 v58, v83, v6
v_fmac_f32 v59, v83, v7
v_lshlrev_b32 v6, 16, v214
v_and_b32 v7, 0xffff0000, v214
v_fmac_f32 v36, v80, v6
v_fmac_f32 v37, v80, v7
v_fmac_f32 v44, v81, v6
v_fmac_f32 v45, v81, v7
v_fmac_f32 v52, v82, v6
v_fmac_f32 v53, v82, v7
v_fmac_f32 v60, v83, v6
v_fmac_f32 v61, v83, v7
v_lshlrev_b32 v6, 16, v215
v_and_b32 v7, 0xffff0000, v215
v_fmac_f32 v38, v80, v6
v_fmac_f32 v39, v80, v7
v_fmac_f32 v46, v81, v6
v_fmac_f32 v47, v81, v7
v_fmac_f32 v54, v82, v6
v_fmac_f32 v55, v82, v7
v_fmac_f32 v62, v83, v6
v_fmac_f32 v63, v83, v7
s_waitcnt vmcnt(3)
v_lshlrev_b32 v6, 16, v216
v_and_b32 v7, 0xffff0000, v216
v_fmac_f32 v32, v84, v6
v_fmac_f32 v33, v84, v7
v_fmac_f32 v40, v85, v6
v_fmac_f32 v41, v85, v7
v_fmac_f32 v48, v86, v6
v_fmac_f32 v49, v86, v7
v_fmac_f32 v56, v87, v6
v_fmac_f32 v57, v87, v7
v_lshlrev_b32 v6, 16, v217
v_and_b32 v7, 0xffff0000, v217
v_fmac_f32 v34, v84, v6
v_fmac_f32 v35, v84, v7
v_fmac_f32 v42, v85, v6
v_fmac_f32 v43, v85, v7
v_fmac_f32 v50, v86, v6
v_fmac_f32 v51, v86, v7
v_fmac_f32 v58, v87, v6
v_fmac_f32 v59, v87, v7
v_lshlrev_b32 v6, 16, v218
v_and_b32 v7, 0xffff0000, v218
v_fmac_f32 v36, v84, v6
v_fmac_f32 v37, v84, v7
v_fmac_f32 v44, v85, v6
v_fmac_f32 v45, v85, v7
v_fmac_f32 v52, v86, v6
v_fmac_f32 v53, v86, v7
v_fmac_f32 v60, v87, v6
v_fmac_f32 v61, v87, v7
v_lshlrev_b32 v6, 16, v219
v_and_b32 v7, 0xffff0000, v219
v_fmac_f32 v38, v84, v6
v_fmac_f32 v39, v84, v7
v_fmac_f32 v46, v85, v6
v_fmac_f32 v47, v85, v7
v_fmac_f32 v54, v86, v6
v_fmac_f32 v55, v86, v7
v_fmac_f32 v62, v87, v6
v_fmac_f32 v63, v87, v7
s_waitcnt vmcnt(2)
v_lshlrev_b32 v6, 16, v220
v_and_b32 v7, 0xffff0000, v220
v_fmac_f32 v32, v88, v6
v_fmac_f32 v33, v88, v7
v_fmac_f32 v40, v89, v6
v_fmac_f32 v41, v89, v7
v_fmac_f32 v48, v90, v6
v_fmac_f32 v49, v90, v7
v_fmac_f32 v56, v91, v6
v_fmac_f32 v57, v91, v7
v_lshlrev_b32 v6, 16, v221
v_and_b32 v7, 0xffff0000, v221
v_fmac_f32 v34, v88, v6
v_fmac_f32 v35, v88, v7
v_fmac_f32 v42, v89, v6
v_fmac_f32 v43, v89, v7
v_fmac_f32 v50, v90, v6
v_fmac_f32 v51, v90, v7
v_fmac_f32 v58, v91, v6
v_fmac_f32 v59, v91, v7
v_lshlrev_b32 v6, 16, v222
v_and_b32 v7, 0xffff0000, v222
v_fmac_f32 v36, v88, v6
v_fmac_f32 v37, v88, v7
v_fmac_f32 v44, v89, v6
v_fmac_f32 v45, v89, v7
v_fmac_f32 v52, v90, v6
v_fmac_f32 v53, v90, v7
v_fmac_f32 v60, v91, v6
v_fmac_f32 v61, v91, v7
v_lshlrev_b32 v6, 16, v223
v_and_b32 v7, 0xffff0000, v223
v_fmac_f32 v38, v88, v6
v_fmac_f32 v39, v88, v7
v_fmac_f32 v46, v89, v6
v_fmac_f32 v47, v89, v7
v_fmac_f32 v54, v90, v6
v_fmac_f32 v55, v90, v7
v_fmac_f32 v62, v91, v6
v_fmac_f32 v63, v91, v7
s_waitcnt vmcnt(1)
v_lshlrev_b32 v6, 16, v224
v_and_b32 v7, 0xffff0000, v224
v_fmac_f32 v32, v92, v6
v_fmac_f32 v33, v92, v7
v_fmac_f32 v40, v93, v6
v_fmac_f32 v41, v93, v7
v_fmac_f32 v48, v94, v6
v_fmac_f32 v49, v94, v7
v_fmac_f32 v56, v95, v6
v_fmac_f32 v57, v95, v7
v_lshlrev_b32 v6, 16, v225
v_and_b32 v7, 0xffff0000, v225
v_fmac_f32 v34, v92, v6
v_fmac_f32 v35, v92, v7
v_fmac_f32 v42, v93, v6
v_fmac_f32 v43, v93, v7
v_fmac_f32 v50, v94, v6
v_fmac_f32 v51, v94, v7
v_fmac_f32 v58, v95, v6
v_fmac_f32 v59, v95, v7
v_lshlrev_b32 v6, 16, v226
v_and_b32 v7, 0xffff0000, v226
v_fmac_f32 v36, v92, v6
v_fmac_f32 v37, v92, v7
v_fmac_f32 v44, v93, v6
v_fmac_f32 v45, v93, v7
v_fmac_f32 v52, v94, v6
v_fmac_f32 v53, v94, v7
v_fmac_f32 v60, v95, v6
v_fmac_f32 v61, v95, v7
v_lshlrev_b32 v6, 16, v227
v_and_b32 v7, 0xffff0000, v227
v_fmac_f32 v38, v92, v6
v_fmac_f32 v39, v92, v7
v_fmac_f32 v46, v93, v6
v_fmac_f32 v47, v93, v7
v_fmac_f32 v54, v94, v6
v_fmac_f32 v55, v94, v7
v_fmac_f32 v62, v95, v6
v_fmac_f32 v63, v95, v7
s_waitcnt vmcnt(0)
v_lshlrev_b32 v6, 16, v228
v_and_b32 v7, 0xffff0000, v228
v_fmac_f32 v32, v96, v6
v_fmac_f32 v33, v96, v7
v_fmac_f32 v40, v97, v6
v_fmac_f32 v41, v97, v7
v_fmac_f32 v48, v98, v6
v_fmac_f32 v49, v98, v7
v_fmac_f32 v56, v99, v6
v_fmac_f32 v57, v99, v7
v_lshlrev_b32 v6, 16, v229
v_and_b32 v7, 0xffff0000, v229
v_fmac_f32 v34, v96, v6
v_fmac_f32 v35, v96, v7
v_fmac_f32 v42, v97, v6
v_fmac_f32 v43, v97, v7
v_fmac_f32 v50, v98, v6
v_fmac_f32 v51, v98, v7
v_fmac_f32 v58, v99, v6
v_fmac_f32 v59, v99, v7
v_lshlrev_b32 v6, 16, v230
v_and_b32 v7, 0xffff0000, v230
v_fmac_f32 v36, v96, v6
v_fmac_f32 v37, v96, v7
v_fmac_f32 v44, v97, v6
v_fmac_f32 v45, v97, v7
v_fmac_f32 v52, v98, v6
v_fmac_f32 v53, v98, v7
v_fmac_f32 v60, v99, v6
v_fmac_f32 v61, v99, v7
v_lshlrev_b32 v6, 16, v231
v_and_b32 v7, 0xffff0000, v231
v_fmac_f32 v38, v96, v6
v_fmac_f32 v39, v96, v7
v_fmac_f32 v46, v97, v6
v_fmac_f32 v47, v97, v7
v_fmac_f32 v54, v98, v6
v_fmac_f32 v55, v98, v7
v_fmac_f32 v62, v99, v6
v_fmac_f32 v63, v99, v7
v_mul_u32_u24 v5, 512, v3
v_lshl_add_u32 v5, v1, 5, v5
ds_write_b128 v5, v[32:35] offset:16384
ds_write_b128 v5, v[36:39] offset:16400
ds_write_b128 v5, v[40:43] offset:16512
ds_write_b128 v5, v[44:47] offset:16528
ds_write_b128 v5, v[48:51] offset:16640
ds_write_b128 v5, v[52:55] offset:16656
ds_write_b128 v5, v[56:59] offset:16768
ds_write_b128 v5, v[60:63] offset:16784
s_waitcnt lgkmcnt(0)
s_barrier
v_lshlrev_b32 v5, 2, v0
v_mov_b32 v10, 0
ds_read_b32 v64, v5 offset:16384
ds_read_b32 v65, v5 offset:16896
ds_read_b32 v66, v5 offset:17408
ds_read_b32 v67, v5 offset:17920
ds_read_b32 v68, v5 offset:18432
ds_read_b32 v69, v5 offset:18944
ds_read_b32 v70, v5 offset:19456
ds_read_b32 v71, v5 offset:19968
ds_read_b32 v72, v5 offset:20480
ds_read_b32 v73, v5 offset:20992
ds_read_b32 v74, v5 offset:21504
ds_read_b32 v75, v5 offset:22016
ds_read_b32 v76, v5 offset:22528
ds_read_b32 v77, v5 offset:23040
ds_read_b32 v78, v5 offset:23552
ds_read_b32 v79, v5 offset:24064
s_waitcnt lgkmcnt(0)
v_add_f32 v10, v10, v64
v_add_f32 v10, v10, v65
v_add_f32 v10, v10, v66
v_add_f32 v10, v10, v67
v_add_f32 v10, v10, v68
v_add_f32 v10, v10, v69
v_add_f32 v10, v10, v70
v_add_f32 v10, v10, v71
v_add_f32 v10, v10, v72
v_add_f32 v10, v10, v73
v_add_f32 v10, v10, v74
v_add_f32 v10, v10, v75
v_add_f32 v10, v10, v76
v_add_f32 v10, v10, v77
v_add_f32 v10, v10, v78
v_add_f32 v10, v10, v79
ds_read_b32 v64, v5 offset:24576
ds_read_b32 v65, v5 offset:25088
ds_read_b32 v66, v5 offset:25600
ds_read_b32 v67, v5 offset:26112
ds_read_b32 v68, v5 offset:26624
ds_read_b32 v69, v5 offset:27136
ds_read_b32 v70, v5 offset:27648
ds_read_b32 v71, v5 offset:28160
ds_read_b32 v72, v5 offset:28672
ds_read_b32 v73, v5 offset:29184
ds_read_b32 v74, v5 offset:29696
ds_read_b32 v75, v5 offset:30208
ds_read_b32 v76, v5 offset:30720
ds_read_b32 v77, v5 offset:31232
ds_read_b32 v78, v5 offset:31744
ds_read_b32 v79, v5 offset:32256
s_waitcnt lgkmcnt(0)
v_add_f32 v10, v10, v64
v_add_f32 v10, v10, v65
v_add_f32 v10, v10, v66
v_add_f32 v10, v10, v67
v_add_f32 v10, v10, v68
v_add_f32 v10, v10, v69
v_add_f32 v10, v10, v70
v_add_f32 v10, v10, v71
v_add_f32 v10, v10, v72
v_add_f32 v10, v10, v73
v_add_f32 v10, v10, v74
v_add_f32 v10, v10, v75
v_add_f32 v10, v10, v76
v_add_f32 v10, v10, v77
v_add_f32 v10, v10, v78
v_add_f32 v10, v10, v79
ds_read_b32 v64, v5 offset:32768
ds_read_b32 v65, v5 offset:33280
ds_read_b32 v66, v5 offset:33792
ds_read_b32 v67, v5 offset:34304
ds_read_b32 v68, v5 offset:34816
ds_read_b32 v69, v5 offset:35328
ds_read_b32 v70, v5 offset:35840
ds_read_b32 v71, v5 offset:36352
ds_read_b32 v72, v5 offset:36864
ds_read_b32 v73, v5 offset:37376
ds_read_b32 v74, v5 offset:37888
ds_read_b32 v75, v5 offset:38400
ds_read_b32 v76, v5 offset:38912
ds_read_b32 v77, v5 offset:39424
ds_read_b32 v78, v5 offset:39936
ds_read_b32 v79, v5 offset:40448
s_waitcnt lgkmcnt(0)
v_add_f32 v10, v10, v64
v_add_f32 v10, v10, v65
v_add_f32 v10, v10, v66
v_add_f32 v10, v10, v67
v_add_f32 v10, v10, v68
v_add_f32 v10, v10, v69
v_add_f32 v10, v10, v70
v_add_f32 v10, v10, v71
v_add_f32 v10, v10, v72
v_add_f32 v10, v10, v73
v_add_f32 v10, v10, v74
v_add_f32 v10, v10, v75
v_add_f32 v10, v10, v76
v_add_f32 v10, v10, v77
v_add_f32 v10, v10, v78
v_add_f32 v10, v10, v79
ds_read_b32 v64, v5 offset:40960
ds_read_b32 v65, v5 offset:41472
ds_read_b32 v66, v5 offset:41984
ds_read_b32 v67, v5 offset:42496
ds_read_b32 v68, v5 offset:43008
ds_read_b32 v69, v5 offset:43520
ds_read_b32 v70, v5 offset:44032
ds_read_b32 v71, v5 offset:44544
ds_read_b32 v72, v5 offset:45056
ds_read_b32 v73, v5 offset:45568
ds_read_b32 v74, v5 offset:46080
ds_read_b32 v75, v5 offset:46592
ds_read_b32 v76, v5 offset:47104
ds_read_b32 v77, v5 offset:47616
ds_read_b32 v78, v5 offset:48128
ds_read_b32 v79, v5 offset:48640
s_waitcnt lgkmcnt(0)
v_add_f32 v10, v10, v64
v_add_f32 v10, v10, v65
v_add_f32 v10, v10, v66
v_add_f32 v10, v10, v67
v_add_f32 v10, v10, v68
v_add_f32 v10, v10, v69
v_add_f32 v10, v10, v70
v_add_f32 v10, v10, v71
v_add_f32 v10, v10, v72
v_add_f32 v10, v10, v73
v_add_f32 v10, v10, v74
v_add_f32 v10, v10, v75
v_add_f32 v10, v10, v76
v_add_f32 v10, v10, v77
v_add_f32 v10, v10, v78
v_add_f32 v10, v10, v79
v_cvt_pk_bf16_f32 v200, v200, v200
v_and_b32 v200, 0xffff0000, v200
v_cvt_pk_bf16_f32 v10, v10, v10
v_and_b32 v10, 0xffff0000, v10
v_mul_f32 v6, 0xbfb8aa3b, v240
v_exp_f32 v6, v6
s_nop 0
v_add_f32 v6, 1.0, v6
v_rcp_f32 v6, v6
s_nop 0
v_mul_f32 v6, v6, v240
v_cvt_pk_bf16_f32 v6, v6, v6
v_and_b32 v6, 0xffff0000, v6
v_mul_f32 v10, v6, v10
v_cvt_pk_bf16_f32 v10, v10, v10
v_lshrrev_b32 v2, 5, v0
v_and_b32 v1, 31, v0
v_mul_u32_u24 v2, 4608, v2
v_add_u32 v2, v2, v1
s_lshl_b32 s25, s2, 5
v_add_u32 v2, s25, v2
v_lshlrev_b32 v2, 1, v2
s_mov_b32 s25, 589824
v_cmp_gt_u32 vcc, 128, v0
s_and_saveexec_b64 s[26:27], vcc
buffer_store_short v10, v2, s[20:23], s25 offen
k4_ffn1_kernel_done:
s_endpgm
.globl k5_down_kernel
.p2align 8
.type k5_down_kernel,@function
k5_down_kernel:
s_cmp_ge_u32 s2, 324
s_cbranch_scc1 k5_down_kernel_done
s_load_dwordx2 s[6:7], s[0:1], 64
s_load_dwordx2 s[8:9], s[0:1], 104
s_waitcnt lgkmcnt(0)
s_mov_b32 s16, s6
s_and_b32 s17, s7, 0xffff
s_mov_b32 s18, 5308416
s_mov_b32 s19, 0x00020000
s_mov_b32 s20, s8
s_and_b32 s21, s9, 0xffff
s_mov_b32 s22, 536870912
s_mov_b32 s23, 0x00020000
s_mul_hi_u32 s24, s2, 0x1c71c71d
s_lshr_b32 s24, s24, 0
s_mul_i32 s25, s24, 9
s_sub_u32 s25, s2, s25
s_mul_i32 s27, s24, 147456
s_lshl_b32 s25, s25, 7
s_add_u32 s27, s27, s25
v_and_b32 v1, 63, v0
v_lshrrev_b32 v2, 6, v0
v_lshrrev_b32 v3, 3, v1
v_and_b32 v1, 7, v1
v_mad_u32_u24 v3, v2, 8, v3
s_mov_b32 s90, 1152
v_mul_lo_u32 v4, v3, s90
v_lshl_add_u32 v4, v1, 4, v4
s_mov_b32 s91, s27
buffer_load_dwordx4 v[160:163], v4, s[16:19], s91 offen
s_add_u32 s91, s91, 36864
buffer_load_dwordx4 v[164:167], v4, s[16:19], s91 offen
s_add_u32 s91, s91, 36864
buffer_load_dwordx4 v[168:171], v4, s[16:19], s91 offen
s_add_u32 s91, s91, 36864
buffer_load_dwordx4 v[172:175], v4, s[16:19], s91 offen
v_and_b32 v1, 127, v0
v_lshrrev_b32 v2, 7, v0
v_mul_u32_u24 v3, 18432, v2
v_lshl_add_u32 v3, v1, 1, v3
s_lshl_b32 s26, s24, 8
s_add_u32 s26, s26, 589824
buffer_load_ushort v64, v3, s[20:23], s26 offen
v_add_u32 v4, 0x2400, v3
buffer_load_ushort v65, v4, s[20:23], s26 offen
v_lshlrev_b32 v7, 4, v1
v_lshl_add_u32 v7, v2, 3, v7
s_waitcnt vmcnt(0)
v_lshlrev_b32 v64, 16, v64
v_lshlrev_b32 v65, 16, v65
ds_write_b64 v7, v[64:65]
s_waitcnt lgkmcnt(0)
s_barrier
v_and_b32 v1, 63, v0
v_lshrrev_b32 v2, 6, v0
v_lshrrev_b32 v3, 3, v1
v_and_b32 v1, 7, v1
v_mad_u32_u24 v3, v2, 8, v3
s_mov_b32 s90, 1152
v_mul_lo_u32 v4, v3, s90
v_lshl_add_u32 v4, v1, 4, v4
s_mov_b32 s91, s27
v_lshlrev_b32 v5, 4, v3
ds_read_b128 v[64:67], v5 offset:0
ds_read_b128 v[68:71], v5 offset:512
ds_read_b128 v[72:75], v5 offset:1024
ds_read_b128 v[76:79], v5 offset:1536
v_mov_b32 v32, 0
v_mov_b32 v33, 0
v_mov_b32 v34, 0
v_mov_b32 v35, 0
v_mov_b32 v36, 0
v_mov_b32 v37, 0
v_mov_b32 v38, 0
v_mov_b32 v39, 0
v_mov_b32 v40, 0
v_mov_b32 v41, 0
v_mov_b32 v42, 0
v_mov_b32 v43, 0
v_mov_b32 v44, 0
v_mov_b32 v45, 0
v_mov_b32 v46, 0
v_mov_b32 v47, 0
v_mov_b32 v48, 0
v_mov_b32 v49, 0
v_mov_b32 v50, 0
v_mov_b32 v51, 0
v_mov_b32 v52, 0
v_mov_b32 v53, 0
v_mov_b32 v54, 0
v_mov_b32 v55, 0
v_mov_b32 v56, 0
v_mov_b32 v57, 0
v_mov_b32 v58, 0
v_mov_b32 v59, 0
v_mov_b32 v60, 0
v_mov_b32 v61, 0
v_mov_b32 v62, 0
v_mov_b32 v63, 0
s_waitcnt lgkmcnt(0)
s_waitcnt vmcnt(3)
v_lshlrev_b32 v6, 16, v160
v_and_b32 v7, 0xffff0000, v160
v_fmac_f32 v32, v64, v6
v_fmac_f32 v33, v64, v7
v_fmac_f32 v40, v65, v6
v_fmac_f32 v41, v65, v7
v_fmac_f32 v48, v66, v6
v_fmac_f32 v49, v66, v7
v_fmac_f32 v56, v67, v6
v_fmac_f32 v57, v67, v7
v_lshlrev_b32 v6, 16, v161
v_and_b32 v7, 0xffff0000, v161
v_fmac_f32 v34, v64, v6
v_fmac_f32 v35, v64, v7
v_fmac_f32 v42, v65, v6
v_fmac_f32 v43, v65, v7
v_fmac_f32 v50, v66, v6
v_fmac_f32 v51, v66, v7
v_fmac_f32 v58, v67, v6
v_fmac_f32 v59, v67, v7
v_lshlrev_b32 v6, 16, v162
v_and_b32 v7, 0xffff0000, v162
v_fmac_f32 v36, v64, v6
v_fmac_f32 v37, v64, v7
v_fmac_f32 v44, v65, v6
v_fmac_f32 v45, v65, v7
v_fmac_f32 v52, v66, v6
v_fmac_f32 v53, v66, v7
v_fmac_f32 v60, v67, v6
v_fmac_f32 v61, v67, v7
v_lshlrev_b32 v6, 16, v163
v_and_b32 v7, 0xffff0000, v163
v_fmac_f32 v38, v64, v6
v_fmac_f32 v39, v64, v7
v_fmac_f32 v46, v65, v6
v_fmac_f32 v47, v65, v7
v_fmac_f32 v54, v66, v6
v_fmac_f32 v55, v66, v7
v_fmac_f32 v62, v67, v6
v_fmac_f32 v63, v67, v7
s_waitcnt vmcnt(2)
v_lshlrev_b32 v6, 16, v164
v_and_b32 v7, 0xffff0000, v164
v_fmac_f32 v32, v68, v6
v_fmac_f32 v33, v68, v7
v_fmac_f32 v40, v69, v6
v_fmac_f32 v41, v69, v7
v_fmac_f32 v48, v70, v6
v_fmac_f32 v49, v70, v7
v_fmac_f32 v56, v71, v6
v_fmac_f32 v57, v71, v7
v_lshlrev_b32 v6, 16, v165
v_and_b32 v7, 0xffff0000, v165
v_fmac_f32 v34, v68, v6
v_fmac_f32 v35, v68, v7
v_fmac_f32 v42, v69, v6
v_fmac_f32 v43, v69, v7
v_fmac_f32 v50, v70, v6
v_fmac_f32 v51, v70, v7
v_fmac_f32 v58, v71, v6
v_fmac_f32 v59, v71, v7
v_lshlrev_b32 v6, 16, v166
v_and_b32 v7, 0xffff0000, v166
v_fmac_f32 v36, v68, v6
v_fmac_f32 v37, v68, v7
v_fmac_f32 v44, v69, v6
v_fmac_f32 v45, v69, v7
v_fmac_f32 v52, v70, v6
v_fmac_f32 v53, v70, v7
v_fmac_f32 v60, v71, v6
v_fmac_f32 v61, v71, v7
v_lshlrev_b32 v6, 16, v167
v_and_b32 v7, 0xffff0000, v167
v_fmac_f32 v38, v68, v6
v_fmac_f32 v39, v68, v7
v_fmac_f32 v46, v69, v6
v_fmac_f32 v47, v69, v7
v_fmac_f32 v54, v70, v6
v_fmac_f32 v55, v70, v7
v_fmac_f32 v62, v71, v6
v_fmac_f32 v63, v71, v7
s_waitcnt vmcnt(1)
v_lshlrev_b32 v6, 16, v168
v_and_b32 v7, 0xffff0000, v168
v_fmac_f32 v32, v72, v6
v_fmac_f32 v33, v72, v7
v_fmac_f32 v40, v73, v6
v_fmac_f32 v41, v73, v7
v_fmac_f32 v48, v74, v6
v_fmac_f32 v49, v74, v7
v_fmac_f32 v56, v75, v6
v_fmac_f32 v57, v75, v7
v_lshlrev_b32 v6, 16, v169
v_and_b32 v7, 0xffff0000, v169
v_fmac_f32 v34, v72, v6
v_fmac_f32 v35, v72, v7
v_fmac_f32 v42, v73, v6
v_fmac_f32 v43, v73, v7
v_fmac_f32 v50, v74, v6
v_fmac_f32 v51, v74, v7
v_fmac_f32 v58, v75, v6
v_fmac_f32 v59, v75, v7
v_lshlrev_b32 v6, 16, v170
v_and_b32 v7, 0xffff0000, v170
v_fmac_f32 v36, v72, v6
v_fmac_f32 v37, v72, v7
v_fmac_f32 v44, v73, v6
v_fmac_f32 v45, v73, v7
v_fmac_f32 v52, v74, v6
v_fmac_f32 v53, v74, v7
v_fmac_f32 v60, v75, v6
v_fmac_f32 v61, v75, v7
v_lshlrev_b32 v6, 16, v171
v_and_b32 v7, 0xffff0000, v171
v_fmac_f32 v38, v72, v6
v_fmac_f32 v39, v72, v7
v_fmac_f32 v46, v73, v6
v_fmac_f32 v47, v73, v7
v_fmac_f32 v54, v74, v6
v_fmac_f32 v55, v74, v7
v_fmac_f32 v62, v75, v6
v_fmac_f32 v63, v75, v7
s_waitcnt vmcnt(0)
v_lshlrev_b32 v6, 16, v172
v_and_b32 v7, 0xffff0000, v172
v_fmac_f32 v32, v76, v6
v_fmac_f32 v33, v76, v7
v_fmac_f32 v40, v77, v6
v_fmac_f32 v41, v77, v7
v_fmac_f32 v48, v78, v6
v_fmac_f32 v49, v78, v7
v_fmac_f32 v56, v79, v6
v_fmac_f32 v57, v79, v7
v_lshlrev_b32 v6, 16, v173
v_and_b32 v7, 0xffff0000, v173
v_fmac_f32 v34, v76, v6
v_fmac_f32 v35, v76, v7
v_fmac_f32 v42, v77, v6
v_fmac_f32 v43, v77, v7
v_fmac_f32 v50, v78, v6
v_fmac_f32 v51, v78, v7
v_fmac_f32 v58, v79, v6
v_fmac_f32 v59, v79, v7
v_lshlrev_b32 v6, 16, v174
v_and_b32 v7, 0xffff0000, v174
v_fmac_f32 v36, v76, v6
v_fmac_f32 v37, v76, v7
v_fmac_f32 v44, v77, v6
v_fmac_f32 v45, v77, v7
v_fmac_f32 v52, v78, v6
v_fmac_f32 v53, v78, v7
v_fmac_f32 v60, v79, v6
v_fmac_f32 v61, v79, v7
v_lshlrev_b32 v6, 16, v175
v_and_b32 v7, 0xffff0000, v175
v_fmac_f32 v38, v76, v6
v_fmac_f32 v39, v76, v7
v_fmac_f32 v46, v77, v6
v_fmac_f32 v47, v77, v7
v_fmac_f32 v54, v78, v6
v_fmac_f32 v55, v78, v7
v_fmac_f32 v62, v79, v6
v_fmac_f32 v63, v79, v7
v_mul_u32_u24 v5, 1024, v3
v_lshl_add_u32 v5, v1, 5, v5
ds_write_b128 v5, v[32:35] offset:16384
ds_write_b128 v5, v[36:39] offset:16400
ds_write_b128 v5, v[40:43] offset:16640
ds_write_b128 v5, v[44:47] offset:16656
ds_write_b128 v5, v[48:51] offset:16896
ds_write_b128 v5, v[52:55] offset:16912
ds_write_b128 v5, v[56:59] offset:17152
ds_write_b128 v5, v[60:63] offset:17168
s_waitcnt lgkmcnt(0)
s_barrier
v_lshlrev_b32 v5, 2, v0
v_mov_b32 v10, 0
ds_read_b32 v64, v5 offset:16384
ds_read_b32 v65, v5 offset:17408
ds_read_b32 v66, v5 offset:18432
ds_read_b32 v67, v5 offset:19456
ds_read_b32 v68, v5 offset:20480
ds_read_b32 v69, v5 offset:21504
ds_read_b32 v70, v5 offset:22528
ds_read_b32 v71, v5 offset:23552
ds_read_b32 v72, v5 offset:24576
ds_read_b32 v73, v5 offset:25600
ds_read_b32 v74, v5 offset:26624
ds_read_b32 v75, v5 offset:27648
ds_read_b32 v76, v5 offset:28672
ds_read_b32 v77, v5 offset:29696
ds_read_b32 v78, v5 offset:30720
ds_read_b32 v79, v5 offset:31744
s_waitcnt lgkmcnt(0)
v_add_f32 v10, v10, v64
v_add_f32 v10, v10, v65
v_add_f32 v10, v10, v66
v_add_f32 v10, v10, v67
v_add_f32 v10, v10, v68
v_add_f32 v10, v10, v69
v_add_f32 v10, v10, v70
v_add_f32 v10, v10, v71
v_add_f32 v10, v10, v72
v_add_f32 v10, v10, v73
v_add_f32 v10, v10, v74
v_add_f32 v10, v10, v75
v_add_f32 v10, v10, v76
v_add_f32 v10, v10, v77
v_add_f32 v10, v10, v78
v_add_f32 v10, v10, v79
ds_read_b32 v64, v5 offset:32768
ds_read_b32 v65, v5 offset:33792
ds_read_b32 v66, v5 offset:34816
ds_read_b32 v67, v5 offset:35840
ds_read_b32 v68, v5 offset:36864
ds_read_b32 v69, v5 offset:37888
ds_read_b32 v70, v5 offset:38912
ds_read_b32 v71, v5 offset:39936
ds_read_b32 v72, v5 offset:40960
ds_read_b32 v73, v5 offset:41984
ds_read_b32 v74, v5 offset:43008
ds_read_b32 v75, v5 offset:44032
ds_read_b32 v76, v5 offset:45056
ds_read_b32 v77, v5 offset:46080
ds_read_b32 v78, v5 offset:47104
ds_read_b32 v79, v5 offset:48128
s_waitcnt lgkmcnt(0)
v_add_f32 v10, v10, v64
v_add_f32 v10, v10, v65
v_add_f32 v10, v10, v66
v_add_f32 v10, v10, v67
v_add_f32 v10, v10, v68
v_add_f32 v10, v10, v69
v_add_f32 v10, v10, v70
v_add_f32 v10, v10, v71
v_add_f32 v10, v10, v72
v_add_f32 v10, v10, v73
v_add_f32 v10, v10, v74
v_add_f32 v10, v10, v75
v_add_f32 v10, v10, v76
v_add_f32 v10, v10, v77
v_add_f32 v10, v10, v78
v_add_f32 v10, v10, v79
v_lshrrev_b32 v2, 6, v0
v_and_b32 v1, 63, v0
v_mul_u32_u24 v2, 2304, v2
v_lshl_add_u32 v2, v1, 2, v2
s_lshl_b32 s25, s25, 1
s_add_u32 s25, s25, 655360
buffer_atomic_add_f32 v10, v2, s[20:23], s25 offen
k5_down_kernel_done:
s_endpgm
.globl k6_fin_kernel
.p2align 8
.type k6_fin_kernel,@function
k6_fin_kernel:
s_cmp_ge_u32 s2, 9
s_cbranch_scc1 k6_fin_kernel_done
s_load_dwordx2 s[4:5], s[0:1], 0
s_load_dwordx2 s[6:7], s[0:1], 88
s_load_dwordx2 s[8:9], s[0:1], 104
s_waitcnt lgkmcnt(0)
s_mov_b32 s12, s4
s_and_b32 s13, s5, 0xffff
s_mov_b32 s14, 4608
s_mov_b32 s15, 0x00020000
s_mov_b32 s16, s6
s_and_b32 s17, s7, 0xffff
s_mov_b32 s18, 4608
s_mov_b32 s19, 0x00020000
s_mov_b32 s20, s8
s_and_b32 s21, s9, 0xffff
s_mov_b32 s22, 536870912
s_mov_b32 s23, 0x00020000
s_lshl_b32 s24, s2, 8
v_add_u32 v1, s24, v0
s_mov_b32 s25, 0x71c72
v_mul_u32_u24 v2, s25, v1
v_lshrrev_b32 v2, 28, v2
v_mul_u32_u24 v3, 2880, v2
v_add_u32 v3, v3, v1
v_lshlrev_b32 v3, 2, v3
v_lshlrev_b32 v4, 2, v1
v_lshlrev_b32 v5, 1, v1
s_mov_b32 s26, 524288
s_mov_b32 s27, 655360
buffer_load_ushort v10, v5, s[12:15], 0 offen
buffer_load_dword v11, v4, s[20:23], s26 offen sc0 sc1
buffer_load_dword v12, v4, s[20:23], s27 offen sc0 sc1
v_add_u32 v3, 0x1200, v3
buffer_load_dword v13, v3, s[20:23], 0 offen
v_add_u32 v3, 0x1b00, v3
buffer_load_dword v14, v3, s[20:23], 0 offen
s_waitcnt vmcnt(0)
v_lshlrev_b32 v10, 16, v10
v_cvt_pk_bf16_f32 v11, v11, v11
v_and_b32 v11, 0xffff0000, v11
v_mul_f32 v11, v11, v13
v_cvt_pk_bf16_f32 v11, v11, v11
v_and_b32 v11, 0xffff0000, v11
v_add_f32 v10, v10, v11
v_cvt_pk_bf16_f32 v10, v10, v10
v_and_b32 v10, 0xffff0000, v10
v_cvt_pk_bf16_f32 v12, v12, v12
v_and_b32 v12, 0xffff0000, v12
v_mul_f32 v12, v12, v14
v_cvt_pk_bf16_f32 v12, v12, v12
v_and_b32 v12, 0xffff0000, v12
v_add_f32 v10, v10, v12
v_cvt_pk_bf16_f32 v10, v10, v10
buffer_store_short v10, v5, s[16:19], 0 offen
k6_fin_kernel_done:
s_endpgm
.section .rodata,"a"
.p2align 6
.amdhsa_kernel k0_mod_kernel
  .amdhsa_next_free_vgpr 248
  .amdhsa_next_free_sgpr 100
  .amdhsa_accum_offset 248
  .amdhsa_group_segment_fixed_size 0
  .amdhsa_kernarg_size 112
  .amdhsa_user_sgpr_count 2
  .amdhsa_user_sgpr_kernarg_segment_ptr 1
  .amdhsa_system_sgpr_workgroup_id_x 1
.end_amdhsa_kernel
.p2align 6
.amdhsa_kernel k1_q_kernel
  .amdhsa_next_free_vgpr 248
  .amdhsa_next_free_sgpr 100
  .amdhsa_accum_offset 248
  .amdhsa_group_segment_fixed_size 0
  .amdhsa_kernarg_size 112
  .amdhsa_user_sgpr_count 2
  .amdhsa_user_sgpr_kernarg_segment_ptr 1
  .amdhsa_system_sgpr_workgroup_id_x 1
.end_amdhsa_kernel
.p2align 6
.amdhsa_kernel k2_attn_kernel
  .amdhsa_next_free_vgpr 248
  .amdhsa_next_free_sgpr 100
  .amdhsa_accum_offset 248
  .amdhsa_group_segment_fixed_size 0
  .amdhsa_kernarg_size 112
  .amdhsa_user_sgpr_count 2
  .amdhsa_user_sgpr_kernarg_segment_ptr 1
  .amdhsa_system_sgpr_workgroup_id_x 1
.end_amdhsa_kernel
.p2align 6
.amdhsa_kernel k3_wo_kernel
  .amdhsa_next_free_vgpr 248
  .amdhsa_next_free_sgpr 100
  .amdhsa_accum_offset 248
  .amdhsa_group_segment_fixed_size 0
  .amdhsa_kernarg_size 112
  .amdhsa_user_sgpr_count 2
  .amdhsa_user_sgpr_kernarg_segment_ptr 1
  .amdhsa_system_sgpr_workgroup_id_x 1
.end_amdhsa_kernel
.p2align 6
.amdhsa_kernel k4_ffn1_kernel
  .amdhsa_next_free_vgpr 248
  .amdhsa_next_free_sgpr 100
  .amdhsa_accum_offset 248
  .amdhsa_group_segment_fixed_size 0
  .amdhsa_kernarg_size 112
  .amdhsa_user_sgpr_count 2
  .amdhsa_user_sgpr_kernarg_segment_ptr 1
  .amdhsa_system_sgpr_workgroup_id_x 1
.end_amdhsa_kernel
.p2align 6
.amdhsa_kernel k5_down_kernel
  .amdhsa_next_free_vgpr 248
  .amdhsa_next_free_sgpr 100
  .amdhsa_accum_offset 248
  .amdhsa_group_segment_fixed_size 0
  .amdhsa_kernarg_size 112
  .amdhsa_user_sgpr_count 2
  .amdhsa_user_sgpr_kernarg_segment_ptr 1
  .amdhsa_system_sgpr_workgroup_id_x 1
.end_amdhsa_kernel
.p2align 6
.amdhsa_kernel k6_fin_kernel
  .amdhsa_next_free_vgpr 32
  .amdhsa_next_free_sgpr 100
  .amdhsa_accum_offset 32
  .amdhsa_group_segment_fixed_size 0
  .amdhsa_kernarg_size 112
  .amdhsa_user_sgpr_count 2
  .amdhsa_user_sgpr_kernarg_segment_ptr 1
  .amdhsa_system_sgpr_workgroup_id_x 1
.end_amdhsa_kernel
```
